```python
import torch

def _softmax(x, axis=-1):
    return torch.softmax(x, dim=axis)
def _gelu(x):
    return torch.nn.functional.gelu(x, approximate="tanh")
def _silu(x):
    return torch.nn.functional.silu(x)
def _sigmoid(x):
    return torch.sigmoid(x)
def _layernorm(x, axis=-1, eps=1e-5):
    m = x.mean(dim=axis, keepdim=True)
    v = x.var(dim=axis, keepdim=True, unbiased=False)
    return (x - m) / torch.sqrt(v + eps)
def _scatter_add(tgt, idx, src, axis=0):
    return tgt.clone().index_add_(axis, idx, src)
def _segment_sum(src, seg, n):
    out = torch.zeros((n,) + src.shape[1:], dtype=src.dtype)
    return out.index_add_(0, seg, src)
def _pad(x, pw):
    flat = tuple(v for pair in reversed(pw) for v in pair)
    return torch.nn.functional.pad(x, flat)

kernel_name = 'interleave_layers__gqa_block_cached__mixer_token_mlp__decode'

def setup_inputs():

    _w = (lambda a: (lambda t: t.to(torch.bfloat16) if t.is_floating_point() else t)(torch.as_tensor(a)))
    def _A_setup():
        B, Sq, D = 2, 1, 512
        Hq, Hkv, Sk, Dh = 32, 32, 8192, 128
        assert Hq % Hkv == 0, (Hq, Hkv)
        return {
            "x": _w((lambda *s: torch.randn(*s, dtype=torch.bfloat16) * 0.05)(B, Sq, D)),
            "k_cache": _w((lambda *s: torch.randn(*s, dtype=torch.bfloat16) * 0.8)(B, Hkv, Sk, Dh)),
            "v_cache": _w((lambda *s: torch.randn(*s, dtype=torch.bfloat16) * 1.6)(B, Hkv, Sk, Dh)),
            "wq": _w((lambda *s: torch.randn(*s, dtype=torch.bfloat16) * 0.8)(D, Hq * Dh) * (D ** -0.5)),
            "wo": _w((lambda *s: torch.randn(*s, dtype=torch.bfloat16) * 1.6)(Hq * Dh, D) * ((Hq * Dh) ** -0.5)),
        }
    _A_in = _A_setup()

    def _B_setup():
        B, S, D, F = 2, 1, 512, 1376
        return {
            "x": _w((lambda *s: torch.randn(*s, dtype=torch.bfloat16) * 0.05)(B, S, D)),
            "w1": _w((lambda *s: torch.randn(*s, dtype=torch.bfloat16) * 0.8)(S, F) * (S ** -0.5)),
            "b1": _w((lambda *s: torch.randn(*s, dtype=torch.bfloat16) * 0.8)(F) * 0.02),
            "w2": _w((lambda *s: torch.randn(*s, dtype=torch.bfloat16) * 0.2)(F, S) * (F ** -0.5)),
            "b2": _w((lambda *s: torch.randn(*s, dtype=torch.bfloat16) * 0.2)(S) * 0.02),
        }
    _B_in = _B_setup()

    return {
        "A_x": _A_in["x"],
        "A_k_cache": _A_in["k_cache"],
        "A_v_cache": _A_in["v_cache"],
        "A_wq": _A_in["wq"],
        "A_wo": _A_in["wo"],
        "B_x": _B_in["x"],
        "B_w1": _B_in["w1"],
        "B_b1": _B_in["b1"],
        "B_w2": _B_in["w2"],
        "B_b2": _B_in["b2"],
    }

def reference(A_x, A_k_cache, A_v_cache, A_wq, A_wo, B_x, B_w1, B_b1, B_w2, B_b2):
    def _A_ref(x, k_cache, v_cache, wq, wo):
        B, Sq, D = x.shape
        Hq, Dh = 32, 128
        Hkv = k_cache.shape[1]
        rep = Hq // Hkv
        q = (lambda x, *d: x.permute(*d))((x @ wq).reshape(B, Sq, Hq, Dh), 0, 2, 1, 3)
        k = (lambda x, n, axis: torch.repeat_interleave(x, n, dim=axis))(k_cache, rep, axis=1)
        v = (lambda x, n, axis: torch.repeat_interleave(x, n, dim=axis))(v_cache, rep, axis=1)
        scores = torch.einsum("bhqd,bhkd->bhqk", q, k) * (Dh ** -0.5)
        p = _softmax(scores, axis=-1)
        o = torch.einsum("bhqk,bhkd->bhqd", p, v)
        return (lambda x, *d: x.permute(*d))(o, 0, 2, 1, 3).reshape(B, Sq, Hq * Dh) @ wo

    def _B_ref(x, w1, b1, w2, b2):
        B, S, D = x.shape
        h = _layernorm(x, axis=-1)
        u = torch.einsum("bsd,sf->bdf", h, w1) + b1
        u = _gelu(u)
        y = torch.einsum("bdf,fs->bds", u, w2) + b2
        return (lambda x, *d: x.permute(*d))(y, 0, 2, 1)

    x = A_x
    x = x + _A_ref(_layernorm(x, axis=-1), A_k_cache, A_v_cache, A_wq, A_wo)
    x = x + _B_ref(_layernorm(x, axis=-1), B_w1, B_b1, B_w2, B_b2)
    x = x + _A_ref(_layernorm(x, axis=-1), A_k_cache, A_v_cache, A_wq, A_wo)
    x = x + _B_ref(_layernorm(x, axis=-1), B_w1, B_b1, B_w2, B_b2)
    return x
```

```asm
; @launch grid=(256,1,1) block=(256,1,1) lds=163840
.amdgcn_target "amdgcn-amd-amdhsa--gfx950"
.text
.globl interleave_layers__gqa_block_cached__mixer_token_mlp__decode_kernel
.p2align 8
.type interleave_layers__gqa_block_cached__mixer_token_mlp__decode_kernel,@function
interleave_layers__gqa_block_cached__mixer_token_mlp__decode_kernel:
    s_cmp_ge_u32 s2, 256
    s_cbranch_scc1 L_end
    s_load_dwordx16 s[32:47], s[0:1], 0
    s_load_dwordx8 s[48:55], s[0:1], 64
    s_load_dwordx2 s[56:57], s[0:1], 96
    s_cmp_ge_u32 s2, 8
    s_cbranch_scc1 L_cp_1
    s_getpc_b64 s[100:101]
L_pc0:
    v_lshlrev_b32_e64 v5, 7, v0
    v_min_u32 v5, L_codeend - L_pc0 - 4, v5
    global_load_dword v178, v5, s[100:101]
L_cp_1:
    v_readfirstlane_b32 s3, v0
    v_and_b32 v4, 63, v0
    v_lshlrev_b32 v0, 4, v4
    s_lshr_b32 s3, s3, 6
    s_and_b32 s4, s2, 7
    s_lshr_b32 s5, s2, 3
    s_and_b32 s31, s5, 3
    s_lshl_b32 s27, s4, 2
    s_add_u32 s6, s31, s27
    s_lshr_b32 s7, s5, 2
    s_lshl_b32 s64, s6, 21
    s_lshl_b32 s27, s7, 18
    s_add_u32 s64, s64, s27
    s_lshl_b32 s27, s3, 12
    s_add_u32 s64, s64, s27
    v_and_b32 v1, 7, v4
    v_lshlrev_b32_e64 v1, 8, v1
    v_bfe_u32 v5, v4, 3, 1
    v_lshl_add_u32 v1, v5, 6, v1
    v_and_b32_e64 v5, 48, v4
    v_add_u32_e64 v1, v1, v5
    s_add_u32 s65, s64, 16384
    s_add_u32 s66, s64, 32768
    s_add_u32 s67, s64, 49152
    s_add_u32 s68, s64, 65536
    s_add_u32 s69, s64, 81920
    s_add_u32 s70, s64, 98304
    s_add_u32 s71, s64, 114688
    s_add_u32 s72, s64, 131072
    s_add_u32 s73, s64, 147456
    s_add_u32 s74, s64, 163840
    s_add_u32 s75, s64, 180224
    s_add_u32 s76, s64, 196608
    s_add_u32 s77, s64, 212992
    s_add_u32 s78, s64, 229376
    s_add_u32 s79, s64, 245760
    s_mov_b32 s10, 0x8000000
    s_mov_b32 s11, 0x20000
    s_waitcnt lgkmcnt(0)
    s_mov_b32 s8, s34
    s_mov_b32 s9, s35
    buffer_load_dwordx4 a[0:3], v1, s[8:11], s64 offen offset:0 nt
    buffer_load_dwordx4 a[4:7], v1, s[8:11], s64 offen offset:128 nt
    buffer_load_dwordx4 a[8:11], v1, s[8:11], s64 offen offset:2048 nt
    buffer_load_dwordx4 a[12:15], v1, s[8:11], s64 offen offset:2176 nt
    buffer_load_dwordx4 a[16:19], v1, s[8:11], s65 offen offset:0 nt
    buffer_load_dwordx4 a[20:23], v1, s[8:11], s65 offen offset:128 nt
    buffer_load_dwordx4 a[24:27], v1, s[8:11], s65 offen offset:2048 nt
    buffer_load_dwordx4 a[28:31], v1, s[8:11], s65 offen offset:2176 nt
    s_mov_b32 s12, s36
    s_mov_b32 s13, s37
    s_mov_b32 s14, 0x8000000
    s_mov_b32 s15, 0x20000
    s_mov_b32 s16, s56
    s_mov_b32 s17, s57
    s_mov_b32 s18, 0x20000000
    s_mov_b32 s19, 0x20000
    s_mov_b32 s23, 0x20000
    s_mov_b32 s20, s32
    s_mov_b32 s21, s33
    s_mov_b32 s22, 2048
    s_mov_b32 s24, 0
    s_lshr_b32 s32, s7, 1
    s_lshl_b32 s27, s32, 2
    s_add_u32 s31, s31, s27
    s_lshl_b32 s27, s32, 2
    v_bfe_u32 v177, v0, 4, 4
    v_add_u32 v177, s27, v177
    v_and_b32 v177, 15, v177
    v_lshlrev_b32 v177, 6, v177
    v_lshrrev_b32 v6, 8, v0
    v_lshl_add_u32 v177, v6, 4, v177
    buffer_load_dwordx4 v[180:183], v177, s[20:23], 0 offen
    buffer_load_dwordx4 v[184:187], v177, s[20:23], 0 offen offset:1024
    v_lshrrev_b32 v2, 5, v4
    s_waitcnt vmcnt(9)
    buffer_load_dwordx4 a[32:35], v1, s[8:11], s66 offen offset:0 nt
    v_lshlrev_b32 v2, 11, v2
    v_bfe_u32 v5, v4, 4, 1
    v_lshl_add_u32 v2, v5, 8, v2
    v_and_b32 v5, 15, v4
    v_lshl_add_u32 v2, v5, 4, v2
    v_and_b32 v5, 1, v4
    v_mul_u32_u24 v5, 0xaaaa, v5
    v_add_u32 v5, 0x4444, v5
    v_and_b32 v6, 3, v4
    v_mul_u32_u24 v6, 0x5555, v6
    v_lshl_add_u32 v3, v6, 16, v5
    s_lshl_b32 s88, s6, 13
    s_lshl_b32 s27, s7, 4
    s_add_u32 s89, s88, s27
    s_lshl_b32 s90, s32, 2
    s_add_u32 s90, s90, s3
    s_lshl_b32 s90, s90, 12
    s_lshl_b32 s27, s6, 7
    s_add_u32 s90, s90, s27
    s_add_u32 s90, s90, 1048576
    s_lshl_b32 s91, s31, 12
    s_add_u32 s91, s91, 1048576
    s_lshl_b32 s93, s4, 11
    s_add_u32 s93, s93, 1310720
    s_lshl_b32 s27, s31, 4
    s_add_u32 s92, s93, s27
    s_lshl_b32 s95, s6, 11
    s_add_u32 s95, s95, 1572864
    s_lshl_b32 s27, s32, 6
    s_add_u32 s94, s95, s27
    s_lshr_b32 s27, s3, 1
    s_lshl_b32 s27, s27, 9
    s_add_u32 s94, s94, s27
    s_and_b32 s27, s3, 1
    s_lshl_b32 s27, s27, 5
    s_add_u32 s94, s94, s27
    s_cmp_lg_u32 s3, 0
    s_cbranch_scc1 L_w_2
    v_mov_b32 v18, 2129920
    buffer_load_dword v179, v18, s[16:19], 0 offen sc1
    v_mov_b32 v8, -1
    v_mov_b32 v9, -1
    v_mov_b32 v10, -1
    v_mov_b32 v11, -1
    s_lshl_b32 s28, s7, 9
    s_add_u32 s28, s28, s88
    v_add_u32 v12, s28, v0
    s_add_u32 s28, s89, 4096
    v_mov_b32 v13, s28
    v_cmp_le_u32 vcc, 32, v4
    s_nop 1
    v_cndmask_b32 v12, v12, v13, vcc
    v_and_b32 v14, 0xf0, v0
    s_lshl_b32 s28, s7, 8
    s_add_u32 s27, s95, s28
    v_add_u32_e64 v15, s27, v14
    v_mov_b32 v16, 0x10000
    s_lshl_b32 s27, s2, 8
    s_add_u32 s27, s27, 1048576
    v_add_u32 v13, s27, v14
    v_cmp_le_u32_e64 vcc, 16, v4
    s_nop 1
    v_cndmask_b32 v15, v15, v13, vcc
    s_lshl_b32 s28, s5, 6
    s_add_u32 s27, s93, s28
    v_add_u32_e64 v13, s27, v14
    v_mov_b32 v17, 0x4000
    v_cmp_le_u32_e64 vcc, 32, v4
    s_nop 0
    s_nop 0
    v_cndmask_b32 v15, v15, v13, vcc
    v_cndmask_b32 v16, v16, v17, vcc
    s_lshl_b32 s27, s31, 3
    s_add_u32 s27, s27, s4
    s_lshl_b32 s27, s27, 7
    s_and_b32 s28, s7, 1
    s_lshl_b32 s28, s28, 6
    s_add_u32 s27, s27, s28
    s_add_u32 s27, s27, 2097152
    v_mov_b32_e64 v13, s27
    v_cmp_le_u32_e64 vcc, 36, v4
    s_nop 0
    s_nop 0
    v_cndmask_b32 v15, v15, v13, vcc
    v_cndmask_b32 v16, v16, 16, vcc
    s_mov_b32 exec_lo, -1
    s_mov_b32 exec_hi, 1
    s_mov_b32 s27, 0
    buffer_store_dwordx4 v[8:11], v12, s[16:19], s27 offen sc1
    s_mov_b32 s27, 262144
    buffer_store_dwordx4 v[8:11], v12, s[16:19], s27 offen sc1
    s_mov_b32 s27, 524288
    buffer_store_dwordx4 v[8:11], v12, s[16:19], s27 offen sc1
    s_mov_b32 s27, 786432
    buffer_store_dwordx4 v[8:11], v12, s[16:19], s27 offen sc1
    s_mov_b32 exec_lo, -1
    s_mov_b32 exec_hi, 31
    buffer_store_dwordx4 v[8:11], v15, s[16:19], 0 offen sc1
    v_add_u32_e64 v15, v15, v16
    buffer_store_dwordx4 v[8:11], v15, s[16:19], 0 offen sc1
    v_add_u32 v15, v15, v16
    buffer_store_dwordx4 v[8:11], v15, s[16:19], 0 offen sc1
    v_add_u32_e64 v15, v15, v16
    buffer_store_dwordx4 v[8:11], v15, s[16:19], 0 offen sc1
    s_mov_b64 exec, -1
L_w_2:
    s_mov_b32 s80, 0xf000f
    s_mov_b32 s81, 0xf000f
    s_mov_b32 s82, 0xf000f0
    s_mov_b32 s83, 0xf000f0
    s_mov_b32 s84, 0xf000f00
    s_mov_b32 s85, 0xf000f00
    s_mov_b32 s86, 0xf000f000
    s_mov_b32 s87, 0xf000f000
    s_mov_b32 s60, 0x3e0293ee
    s_mov_b32 s26, 400000
    s_mul_i32 s30, s3, 16384
    s_add_u32 s30, s30, 86016
    s_lshl_b32 s33, s6, 17
    s_lshl_b32 s28, s3, 15
    s_add_u32 s33, s33, s28
    s_lshl_b32 s28, s32, 8
    s_add_u32 s33, s33, s28
    s_mov_b32 s61, 0
    s_mov_b32 s34, 0
    s_mul_i32 s37, s3, 20480
    s_add_u32 s37, s37, 4096
    s_mul_i32 s27, s3, 3072
    s_add_u32 s27, s27, 151552
    s_bitcmp1_b32 s7, 0
    s_cselect_b32 s37, s37, s27
    s_bitcmp1_b32 s7, 0
    s_cbranch_scc1 L_pro_odd
    s_mov_b32 s20, s38
    s_mov_b32 s21, s39
    s_mov_b32 s22, 0x400000
    s_mov_b32 s44, s40
    s_mov_b32 s45, s41
    s_mov_b32 s46, 0x400000
    s_mov_b32 s47, 0x20000
    v_lshrrev_b32 v7, 4, v4
    v_and_b32 v6, 0xf0, v0
    v_lshlrev_b32 v5, 5, v7
    v_xor_b32 v6, v6, v5
    v_lshl_add_u32 v212, v7, 13, v6
    v_xor_b32 v213, 0x80, v212
    v_lshl_add_u32 v214, v7, 10, v6
    v_xor_b32 v215, 0x80, v214
    s_lshl_b32 s40, s32, 20
    s_lshl_b32 s28, s3, 18
    s_add_u32 s40, s40, s28
    s_lshl_b32 s28, s6, 8
    s_add_u32 s40, s40, s28
    s_lshl_b32 s42, s3, 13
    s_waitcnt vmcnt(9)
    s_add_u32 m0, s42, 20480
    s_nop 0
    buffer_load_dwordx4 v212, s[20:23], s40 offen nt lds
    s_add_u32 s40, s40, 0x8000
    s_waitcnt vmcnt(9)
    s_add_u32 m0, s42, 21504
    s_nop 0
    buffer_load_dwordx4 v212, s[20:23], s40 offen nt lds
    s_add_u32 s40, s40, 0x8000
    s_waitcnt vmcnt(9)
    s_add_u32 m0, s42, 22528
    s_nop 0
    buffer_load_dwordx4 v213, s[20:23], s40 offen nt lds
    s_add_u32 s40, s40, 0x8000
    s_waitcnt vmcnt(9)
    s_add_u32 m0, s42, 23552
    s_nop 0
    buffer_load_dwordx4 v213, s[20:23], s40 offen nt lds
    s_add_u32 s40, s40, 0x8000
    s_waitcnt vmcnt(9)
    s_add_u32 m0, s42, 24576
    s_nop 0
    buffer_load_dwordx4 v212, s[20:23], s40 offen nt lds
    s_add_u32 s40, s40, 0x8000
    s_waitcnt vmcnt(9)
    s_add_u32 m0, s42, 25600
    s_nop 0
    buffer_load_dwordx4 v212, s[20:23], s40 offen nt lds
    s_add_u32 s40, s40, 0x8000
    s_waitcnt vmcnt(9)
    s_add_u32 m0, s42, 26624
    s_nop 0
    buffer_load_dwordx4 v213, s[20:23], s40 offen nt lds
    s_add_u32 s40, s40, 0x8000
    s_waitcnt vmcnt(9)
    s_add_u32 m0, s42, 27648
    s_nop 0
    buffer_load_dwordx4 v213, s[20:23], s40 offen nt lds
    s_add_u32 s40, s40, 0x8000
    s_waitcnt vmcnt(8)
    s_cmp_lg_u32 s3, 0
    s_cbranch_scc1 L_w_3
    v_readfirstlane_b32 s27, v179
    s_mul_i32 s35, s27, 0x9e3779b1
    s_add_u32 s35, s35, 0x7f4a7c15
    s_cmp_eq_u32 s35, s27
    s_addc_u32 s35, s35, 0
    s_getreg_b32 s25, hwreg(HW_REG_XCC_ID, 0, 4)
    s_not_b32 s27, s35
    s_xor_b32 s25, s25, s27
    v_mov_b32 v6, s35
    v_mov_b32_e64 v7, s25
    v_mov_b32 v5, 0
    s_lshl_b32 s27, s4, 9
    s_lshl_b32 s28, s5, 4
    s_add_u32 s27, s27, s28
    s_add_u32 s27, s27, 2113536
    s_mov_b32 exec_lo, 1
    s_mov_b32 exec_hi, 0
    buffer_store_dwordx2 v[6:7], v5, s[16:19], s27 offen sc1
    s_mov_b64 exec, -1
L_w_3:
    s_waitcnt vmcnt(9)
    buffer_load_dwordx4 a[36:39], v1, s[8:11], s66 offen offset:128 nt
    s_waitcnt vmcnt(9)
    buffer_load_dwordx4 a[40:43], v1, s[8:11], s66 offen offset:2048 nt
    s_waitcnt vmcnt(9)
    buffer_load_dwordx4 a[44:47], v1, s[8:11], s66 offen offset:2176 nt
    s_waitcnt vmcnt(9)
    buffer_load_dwordx4 a[48:51], v1, s[8:11], s67 offen offset:0 nt
    s_waitcnt vmcnt(9)
    buffer_load_dwordx4 a[52:55], v1, s[8:11], s67 offen offset:128 nt
    s_waitcnt vmcnt(9)
    buffer_load_dwordx4 a[56:59], v1, s[8:11], s67 offen offset:2048 nt
    s_waitcnt vmcnt(9)
    buffer_load_dwordx4 a[60:63], v1, s[8:11], s67 offen offset:2176 nt
    s_waitcnt vmcnt(9)
    buffer_load_dwordx4 a[64:67], v1, s[8:11], s68 offen offset:0 nt
    s_waitcnt vmcnt(9)
    buffer_load_dwordx4 a[68:71], v1, s[8:11], s68 offen offset:128 nt
    s_waitcnt vmcnt(9)
    buffer_load_dwordx4 a[72:75], v1, s[8:11], s68 offen offset:2048 nt
    s_waitcnt vmcnt(9)
    buffer_load_dwordx4 a[76:79], v1, s[8:11], s68 offen offset:2176 nt
    s_waitcnt vmcnt(9)
    buffer_load_dwordx4 a[80:83], v1, s[8:11], s69 offen offset:0 nt
    s_waitcnt vmcnt(9)
    buffer_load_dwordx4 a[84:87], v1, s[8:11], s69 offen offset:128 nt
    s_waitcnt vmcnt(9)
    buffer_load_dwordx4 a[88:91], v1, s[8:11], s69 offen offset:2048 nt
    s_waitcnt vmcnt(9)
    buffer_load_dwordx4 a[92:95], v1, s[8:11], s69 offen offset:2176 nt
    s_waitcnt vmcnt(9)
    buffer_load_dwordx4 a[96:99], v1, s[8:11], s70 offen offset:0 nt
    v_and_b32 v5, 0x1f0, v0
    s_waitcnt vmcnt(9)
    buffer_load_dwordx4 a[100:103], v1, s[8:11], s70 offen offset:128 nt
    s_lshl_b32 s29, s4, 9
    s_add_u32 s29, s29, 2113536
    s_cmp_lg_u32 s3, 0
    s_cbranch_scc1 L_w_6
    buffer_load_dwordx2 v[6:7], v5, s[16:19], s29 offen sc1
L_w_6:
    s_waitcnt vmcnt(9)
    buffer_load_dwordx4 a[104:107], v1, s[8:11], s70 offen offset:2048 nt
    s_waitcnt vmcnt(9)
    buffer_load_dwordx4 a[108:111], v1, s[8:11], s70 offen offset:2176 nt
    s_waitcnt vmcnt(9)
    buffer_load_dwordx4 a[112:115], v1, s[8:11], s71 offen offset:0 nt
    s_waitcnt vmcnt(9)
    buffer_load_dwordx4 a[116:119], v1, s[8:11], s71 offen offset:128 nt
    s_waitcnt vmcnt(9)
    buffer_load_dwordx4 a[120:123], v1, s[8:11], s71 offen offset:2048 nt
    s_waitcnt vmcnt(9)
    buffer_load_dwordx4 a[124:127], v1, s[8:11], s71 offen offset:2176 nt
    s_waitcnt vmcnt(9)
    buffer_load_dwordx4 a[128:131], v1, s[8:11], s72 offen offset:0 nt
    s_waitcnt vmcnt(9)
    buffer_load_dwordx4 a[132:135], v1, s[8:11], s72 offen offset:128 nt
    s_waitcnt vmcnt(8)
    s_cmp_lg_u32 s3, 0
    s_cbranch_scc1 L_w_7
L_gbc_5:
    v_xor_b32 v10, s25, v7
    v_xor_b32 v11, s35, v6
    v_lshrrev_b32 v12, 4, v10
    v_or_b32 v11, v11, v12
    v_cmp_ne_u32 vcc, 0, v11
    s_cbranch_vccnz L_gbr_4
    v_cmp_ne_u32 vcc, 0, v10
    s_cmp_eq_u64 vcc, 0
    s_cselect_b32 s25, 1, 0
    s_cmp_lg_u32 s5, 0
    s_cbranch_scc1 L_lead_8
    s_lshl_b32 s27, s4, 2
    s_add_u32 s27, s27, 2121728
    v_lshlrev_b32 v7, 4, v0
    s_mov_b32 exec_lo, 65535
    s_mov_b32 exec_hi, 0
    buffer_store_dword v6, v7, s[16:19], s27 offen sc1
    s_mov_b64 exec, -1
L_lead_8:
    v_mov_b32 v10, s25
    v_mov_b32_e64 v11, s35
    v_mov_b32_e64 v7, 0
    ds_write_b64 v7, v[10:11] offset:2368
    s_waitcnt lgkmcnt(0)
L_w_7:
    s_barrier
    v_mov_b32 v7, 0
    s_waitcnt vmcnt(9)
    buffer_load_dwordx4 a[136:139], v1, s[8:11], s72 offen offset:2048 nt
    ds_read_b64 v[10:11], v7 offset:2368
    s_waitcnt lgkmcnt(0)
    v_readfirstlane_b32 s25, v10
    v_readfirstlane_b32 s35, v11
    v_lshlrev_b32_e64 v46, 1, v177
    s_lshl_b32 s27, s3, 1
    v_bfe_u32 v45, v0, 6, 3
    v_xor_b32_e64 v45, s27, v45
    v_bfe_u32 v44, v0, 4, 2
    v_lshl_add_u32 v45, v45, 2, v44
    v_bfe_u32 v44, v0, 6, 2
    v_lshl_add_u32 v45, v44, 5, v45
    v_lshrrev_b32_e64 v44, 8, v0
    v_lshl_add_u32 v45, v44, 8, v45
    v_lshlrev_b32_e64 v45, 3, v45
    v_add_u32 v45, 20480, v45
    v_xor_b32 v44, 32, v45
    ds_read_b64_tr_b16 v[24:25], v45 offset:0
    ds_read_b64_tr_b16 v[26:27], v45 offset:1024
    ds_read_b64_tr_b16 v[28:29], v45 offset:8192
    ds_read_b64_tr_b16 v[30:31], v45 offset:9216
    ds_read_b64_tr_b16 v[32:33], v45 offset:16384
    ds_read_b64_tr_b16 v[34:35], v45 offset:17408
    ds_read_b64_tr_b16 v[36:37], v45 offset:24576
    s_waitcnt vmcnt(9)
    buffer_load_dwordx4 a[140:143], v1, s[8:11], s72 offen offset:2176 nt
    ds_read_b64_tr_b16 v[38:39], v45 offset:25600
    ds_read_b64_tr_b16 v[48:49], v44 offset:0
    ds_read_b64_tr_b16 v[50:51], v44 offset:1024
    ds_read_b64_tr_b16 v[52:53], v44 offset:8192
    ds_read_b64_tr_b16 v[54:55], v44 offset:9216
    ds_read_b64_tr_b16 v[56:57], v44 offset:16384
    ds_read_b64_tr_b16 v[58:59], v44 offset:17408
    ds_read_b64_tr_b16 v[60:61], v44 offset:24576
    ds_read_b64_tr_b16 v[62:63], v44 offset:25600
    v_lshlrev_b32_e64 v8, 16, v180
    v_and_b32 v9, 0xffff0000, v180
    v_lshlrev_b32_e64 v10, 16, v181
    v_and_b32 v11, 0xffff0000, v181
    v_lshlrev_b32_e64 v12, 16, v182
    v_and_b32 v13, 0xffff0000, v182
    v_lshlrev_b32 v14, 16, v183
    v_and_b32 v15, 0xffff0000, v183
    s_mov_b32 s61, 0
    v_pk_add_f32 v[16:17], v[8:9], v[10:11]
    v_pk_mul_f32 v[20:21], v[8:9], v[8:9]
    v_pk_add_f32 v[18:19], v[12:13], v[14:15]
    v_pk_fma_f32 v[20:21], v[10:11], v[10:11], v[20:21]
    v_pk_add_f32 v[16:17], v[16:17], v[18:19]
    v_pk_fma_f32 v[20:21], v[12:13], v[12:13], v[20:21]
    s_waitcnt vmcnt(9)
    buffer_load_dwordx4 a[144:147], v1, s[8:11], s73 offen offset:0 nt
    v_add_f32 v16, v16, v17
    v_pk_fma_f32 v[20:21], v[14:15], v[14:15], v[20:21]
    v_add_f32_e64 v20, v20, v21
    v_bfe_u32 v44, v0, 5, 1
    v_bfe_u32 v45, v0, 7, 1
    v_permlane32_swap_b32 v16, v20
    v_add_f32 v16, v16, v20
    v_mov_b32 v20, v16
    v_lshlrev_b32 v44, 4, v44
    v_lshl_add_u32 v44, v45, 10, v44
    v_permlane16_swap_b32 v20, v16
    v_add_f32 v16, v16, v20
    v_bfe_u32 v45, v0, 6, 1
    v_lshl_add_u32 v44, v45, 3, v44
    v_add_f32_dpp v16, v16, v16 row_ror:1 row_mask:0xf bank_mask:0xf
    v_bfe_u32 v45, v0, 4, 1
    v_lshl_add_u32 v44, v45, 2, v44
    v_add_f32_dpp v16, v16, v16 row_ror:2 row_mask:0xf bank_mask:0xf
    v_and_b32 v45, 0x100, v0
    v_add_u32 v44, v44, v45
    v_add_f32_dpp v16, v16, v16 row_ror:4 row_mask:0xf bank_mask:0xf
    v_mov_b32 v19, 0x3727c5ac
    s_nop 0
    v_add_f32_dpp v16, v16, v16 row_ror:8 row_mask:0xf bank_mask:0xf
    v_mul_f32 v16, 0x3b000000, v16
    s_waitcnt vmcnt(9)
    buffer_load_dwordx4 a[148:151], v1, s[8:11], s73 offen offset:128 nt
    v_mov_b32 v20, v16
    s_nop 1
    v_permlane32_swap_b32 v16, v20
    v_fma_f32 v20, -v16, v16, v20
    v_add_f32 v20, abs(v20), v19
    v_rsq_f32 v40, v20
    s_waitcnt lgkmcnt(0)
    v_pk_add_f32 v[22:23], v[14:15], v[16:17] op_sel_hi:[1,0] neg_lo:[0,1] neg_hi:[0,1]
    v_pk_add_f32 v[20:21], v[12:13], v[16:17] op_sel_hi:[1,0] neg_lo:[0,1] neg_hi:[0,1]
    v_pk_add_f32 v[18:19], v[10:11], v[16:17] op_sel_hi:[1,0] neg_lo:[0,1] neg_hi:[0,1]
    v_pk_add_f32 v[16:17], v[8:9], v[16:17] op_sel_hi:[1,0] neg_lo:[0,1] neg_hi:[0,1]
    v_pk_mul_f32 v[22:23], v[22:23], v[40:41] op_sel_hi:[1,0]
    v_pk_mul_f32 v[20:21], v[20:21], v[40:41] op_sel_hi:[1,0]
    v_pk_mul_f32 v[18:19], v[18:19], v[40:41] op_sel_hi:[1,0]
    v_pk_mul_f32 v[16:17], v[16:17], v[40:41] op_sel_hi:[1,0]
    v_cvt_pk_bf16_f32 v4, v16, v17
    v_cvt_pk_bf16_f32 v5, v18, v19
    v_cvt_pk_bf16_f32 v6, v20, v21
    v_cvt_pk_bf16_f32 v7, v22, v23
    v_mov_b64_dpp v[16:17], v[4:5] row_newbcast:1 row_mask:0xf bank_mask:0xf
    s_nop 0
    v_mfma_f32_16x16x32_bf16 v[40:43], v[4:7], v[24:27], 0
    v_mov_b64_dpp v[18:19], v[6:7] row_newbcast:1 row_mask:0xf bank_mask:0xf
    v_mfma_f32_16x16x32_bf16 v[24:27], v[4:7], v[48:51], 0
    v_mov_b64_dpp v[20:21], v[4:5] row_newbcast:2 row_mask:0xf bank_mask:0xf
    v_mov_b64_dpp v[22:23], v[6:7] row_newbcast:2 row_mask:0xf bank_mask:0xf
    s_waitcnt vmcnt(9)
    buffer_load_dwordx4 a[152:155], v1, s[8:11], s73 offen offset:2048 nt
    v_mfma_f32_16x16x32_bf16 v[40:43], v[16:19], v[28:31], v[40:43]
    v_mfma_f32_16x16x32_bf16 v[24:27], v[16:19], v[52:55], v[24:27]
    v_mov_b64_dpp v[16:17], v[4:5] row_newbcast:3 row_mask:0xf bank_mask:0xf
    v_mov_b64_dpp v[18:19], v[6:7] row_newbcast:3 row_mask:0xf bank_mask:0xf
    v_mfma_f32_16x16x32_bf16 v[40:43], v[20:23], v[32:35], v[40:43]
    v_mfma_f32_16x16x32_bf16 v[24:27], v[20:23], v[56:59], v[24:27]
    v_mfma_f32_16x16x32_bf16 v[40:43], v[16:19], v[36:39], v[40:43]
    v_mfma_f32_16x16x32_bf16 v[24:27], v[16:19], v[60:63], v[24:27]
    s_cmp_eq_u32 s25, 0
    s_nop 6
    v_permlane16_swap_b32 v40, v24
    s_mov_b32 exec_lo, -1
    s_mov_b32 exec_hi, 0
    s_cbranch_scc1 L_slow_9
    buffer_store_dword v40, v44, s[16:19], s94 offen
L_slowb_10:
    s_mov_b64 exec, -1
    s_cmp_lg_u32 s3, 0
    s_cbranch_scc1 L_w_11
    v_lshrrev_b32 v44, 7, v46
    v_and_b32 v45, 0x60, v46
    v_cmp_eq_u32_e64 vcc, s31, v44
    v_add_u32_e64 v45, s61, v45
    s_mov_b64 exec, vcc
    ds_write_b128 v45, v[8:11] offset:2112
    ds_write_b128 v45, v[12:15] offset:2128
    s_mov_b64 exec, -1
L_w_11:
    s_add_u32 s94, s94, 0x20000
    s_lshl_b32 s27, s3, 1
    v_bfe_u32 v45, v0, 6, 3
    s_waitcnt vmcnt(9)
    buffer_load_dwordx4 a[156:159], v1, s[8:11], s73 offen offset:2176 nt
    v_xor_b32_e64 v45, s27, v45
    v_bfe_u32 v44, v0, 4, 2
    v_lshl_add_u32 v45, v45, 2, v44
    v_bfe_u32 v44, v0, 6, 2
    v_lshl_add_u32 v45, v44, 5, v45
    v_lshrrev_b32_e64 v44, 8, v0
    v_lshl_add_u32 v45, v44, 8, v45
    v_lshlrev_b32_e64 v45, 3, v45
    v_add_u32 v45, 20480, v45
    v_xor_b32_e64 v44, 32, v45
    ds_read_b64_tr_b16 v[24:25], v45 offset:0
    ds_read_b64_tr_b16 v[26:27], v45 offset:1024
    ds_read_b64_tr_b16 v[28:29], v45 offset:8192
    ds_read_b64_tr_b16 v[30:31], v45 offset:9216
    ds_read_b64_tr_b16 v[32:33], v45 offset:16384
    ds_read_b64_tr_b16 v[34:35], v45 offset:17408
    ds_read_b64_tr_b16 v[36:37], v45 offset:24576
    ds_read_b64_tr_b16 v[38:39], v45 offset:25600
    ds_read_b64_tr_b16 v[48:49], v44 offset:0
    ds_read_b64_tr_b16 v[50:51], v44 offset:1024
    ds_read_b64_tr_b16 v[52:53], v44 offset:8192
    ds_read_b64_tr_b16 v[54:55], v44 offset:9216
    ds_read_b64_tr_b16 v[56:57], v44 offset:16384
    ds_read_b64_tr_b16 v[58:59], v44 offset:17408
    s_waitcnt vmcnt(9)
    buffer_load_dwordx4 a[160:163], v1, s[8:11], s74 offen offset:0 nt
    ds_read_b64_tr_b16 v[60:61], v44 offset:24576
    ds_read_b64_tr_b16 v[62:63], v44 offset:25600
    v_lshlrev_b32 v8, 16, v184
    v_and_b32 v9, 0xffff0000, v184
    v_lshlrev_b32 v10, 16, v185
    v_and_b32 v11, 0xffff0000, v185
    v_lshlrev_b32 v12, 16, v186
    v_and_b32 v13, 0xffff0000, v186
    v_lshlrev_b32_e64 v14, 16, v187
    v_and_b32 v15, 0xffff0000, v187
    s_mov_b32 s61, 128
    v_pk_add_f32 v[16:17], v[8:9], v[10:11]
    v_pk_mul_f32 v[20:21], v[8:9], v[8:9]
    v_pk_add_f32 v[18:19], v[12:13], v[14:15]
    v_pk_fma_f32 v[20:21], v[10:11], v[10:11], v[20:21]
    v_pk_add_f32 v[16:17], v[16:17], v[18:19]
    v_pk_fma_f32 v[20:21], v[12:13], v[12:13], v[20:21]
    v_add_f32 v16, v16, v17
    v_pk_fma_f32 v[20:21], v[14:15], v[14:15], v[20:21]
    v_add_f32 v20, v20, v21
    v_bfe_u32 v44, v0, 5, 1
    v_bfe_u32 v45, v0, 7, 1
    v_permlane32_swap_b32 v16, v20
    v_add_f32 v16, v16, v20
    s_waitcnt vmcnt(9)
    buffer_load_dwordx4 a[164:167], v1, s[8:11], s74 offen offset:128 nt
    v_mov_b32 v20, v16
    v_lshlrev_b32 v44, 4, v44
    v_lshl_add_u32 v44, v45, 10, v44
    v_permlane16_swap_b32 v20, v16
    v_add_f32_e64 v16, v16, v20
    v_bfe_u32 v45, v0, 6, 1
    v_lshl_add_u32 v44, v45, 3, v44
    v_add_f32_dpp v16, v16, v16 row_ror:1 row_mask:0xf bank_mask:0xf
    v_bfe_u32 v45, v0, 4, 1
    v_lshl_add_u32 v44, v45, 2, v44
    v_add_f32_dpp v16, v16, v16 row_ror:2 row_mask:0xf bank_mask:0xf
    v_and_b32 v45, 0x100, v0
    v_add_u32_e64 v44, v44, v45
    v_add_f32_dpp v16, v16, v16 row_ror:4 row_mask:0xf bank_mask:0xf
    v_mov_b32 v19, 0x3727c5ac
    s_nop 0
    v_add_f32_dpp v16, v16, v16 row_ror:8 row_mask:0xf bank_mask:0xf
    v_mul_f32 v16, 0x3b000000, v16
    v_mov_b32 v20, v16
    s_nop 1
    v_permlane32_swap_b32 v16, v20
    v_fma_f32 v20, -v16, v16, v20
    v_add_f32 v20, abs(v20), v19
    v_rsq_f32_e64 v40, v20
    s_waitcnt lgkmcnt(0)
    v_pk_add_f32 v[22:23], v[14:15], v[16:17] op_sel_hi:[1,0] neg_lo:[0,1] neg_hi:[0,1]
    s_waitcnt vmcnt(9)
    buffer_load_dwordx4 a[168:171], v1, s[8:11], s74 offen offset:2048 nt
    v_pk_add_f32 v[20:21], v[12:13], v[16:17] op_sel_hi:[1,0] neg_lo:[0,1] neg_hi:[0,1]
    v_pk_add_f32 v[18:19], v[10:11], v[16:17] op_sel_hi:[1,0] neg_lo:[0,1] neg_hi:[0,1]
    v_pk_add_f32 v[16:17], v[8:9], v[16:17] op_sel_hi:[1,0] neg_lo:[0,1] neg_hi:[0,1]
    v_pk_mul_f32 v[22:23], v[22:23], v[40:41] op_sel_hi:[1,0]
    v_pk_mul_f32 v[20:21], v[20:21], v[40:41] op_sel_hi:[1,0]
    v_pk_mul_f32 v[18:19], v[18:19], v[40:41] op_sel_hi:[1,0]
    v_pk_mul_f32 v[16:17], v[16:17], v[40:41] op_sel_hi:[1,0]
    v_cvt_pk_bf16_f32 v4, v16, v17
    v_cvt_pk_bf16_f32 v5, v18, v19
    v_cvt_pk_bf16_f32 v6, v20, v21
    v_cvt_pk_bf16_f32 v7, v22, v23
    v_mov_b64_dpp v[16:17], v[4:5] row_newbcast:1 row_mask:0xf bank_mask:0xf
    s_nop 0
    v_mfma_f32_16x16x32_bf16 v[40:43], v[4:7], v[24:27], 0
    v_mov_b64_dpp v[18:19], v[6:7] row_newbcast:1 row_mask:0xf bank_mask:0xf
    v_mfma_f32_16x16x32_bf16 v[24:27], v[4:7], v[48:51], 0
    v_mov_b64_dpp v[20:21], v[4:5] row_newbcast:2 row_mask:0xf bank_mask:0xf
    v_mov_b64_dpp v[22:23], v[6:7] row_newbcast:2 row_mask:0xf bank_mask:0xf
    v_mfma_f32_16x16x32_bf16 v[40:43], v[16:19], v[28:31], v[40:43]
    v_mfma_f32_16x16x32_bf16 v[24:27], v[16:19], v[52:55], v[24:27]
    v_mov_b64_dpp v[16:17], v[4:5] row_newbcast:3 row_mask:0xf bank_mask:0xf
    v_mov_b64_dpp v[18:19], v[6:7] row_newbcast:3 row_mask:0xf bank_mask:0xf
    v_mfma_f32_16x16x32_bf16 v[40:43], v[20:23], v[32:35], v[40:43]
    v_mfma_f32_16x16x32_bf16 v[24:27], v[20:23], v[56:59], v[24:27]
    v_mfma_f32_16x16x32_bf16 v[40:43], v[16:19], v[36:39], v[40:43]
    s_waitcnt vmcnt(9)
    buffer_load_dwordx4 a[172:175], v1, s[8:11], s74 offen offset:2176 nt
    v_mfma_f32_16x16x32_bf16 v[24:27], v[16:19], v[60:63], v[24:27]
    s_cmp_eq_u32 s25, 0
    s_nop 6
    v_permlane16_swap_b32 v40, v24
    s_mov_b32 exec_lo, -1
    s_mov_b32 exec_hi, 0
    s_cbranch_scc1 L_slow_12
    buffer_store_dword v40, v44, s[16:19], s94 offen
L_slowb_13:
    s_mov_b64 exec, -1
    s_cmp_lg_u32 s3, 0
    s_cbranch_scc1 L_w_14
    v_lshrrev_b32 v44, 7, v46
    v_and_b32 v45, 0x60, v46
    v_cmp_eq_u32 vcc, s31, v44
    v_add_u32_e64 v45, s61, v45
    s_mov_b64 exec, vcc
    ds_write_b128 v45, v[8:11] offset:2112
    ds_write_b128 v45, v[12:15] offset:2128
    s_mov_b64 exec, -1
L_w_14:
    s_add_u32 s94, s94, 0xffff0000
    s_mov_b32 s61, 0
    s_waitcnt vmcnt(9)
    buffer_load_dwordx4 a[176:179], v1, s[8:11], s75 offen offset:0 nt
    s_add_u32 m0, s42, 53248
    s_nop 0
    buffer_load_dwordx4 v214, s[44:47], s33 offen nt lds
    s_add_u32 s33, s33, 0x1000
    s_waitcnt vmcnt(9)
    buffer_load_dwordx4 a[180:183], v1, s[8:11], s75 offen offset:128 nt
    s_add_u32 m0, s42, 54272
    s_nop 0
    buffer_load_dwordx4 v214, s[44:47], s33 offen nt lds
    s_add_u32 s33, s33, 0x1000
    s_waitcnt vmcnt(9)
    buffer_load_dwordx4 a[184:187], v1, s[8:11], s75 offen offset:2048 nt
    s_add_u32 m0, s42, 55296
    s_nop 0
    buffer_load_dwordx4 v215, s[44:47], s33 offen nt lds
    s_add_u32 s33, s33, 0x1000
    s_waitcnt vmcnt(9)
    buffer_load_dwordx4 a[188:191], v1, s[8:11], s75 offen offset:2176 nt
    s_add_u32 m0, s42, 56320
    s_nop 0
    buffer_load_dwordx4 v215, s[44:47], s33 offen nt lds
    s_add_u32 s33, s33, 0x1000
    s_waitcnt vmcnt(9)
    buffer_load_dwordx4 a[192:195], v1, s[8:11], s76 offen offset:0 nt
    s_add_u32 m0, s42, 57344
    s_nop 0
    buffer_load_dwordx4 v214, s[44:47], s33 offen nt lds
    s_add_u32 s33, s33, 0x1000
    s_waitcnt vmcnt(9)
    buffer_load_dwordx4 a[196:199], v1, s[8:11], s76 offen offset:128 nt
    s_add_u32 m0, s42, 58368
    s_nop 0
    buffer_load_dwordx4 v214, s[44:47], s33 offen nt lds
    s_add_u32 s33, s33, 0x1000
    s_waitcnt vmcnt(9)
    buffer_load_dwordx4 a[200:203], v1, s[8:11], s76 offen offset:2048 nt
    s_add_u32 m0, s42, 59392
    s_nop 0
    buffer_load_dwordx4 v215, s[44:47], s33 offen nt lds
    s_add_u32 s33, s33, 0x1000
    s_waitcnt vmcnt(9)
    buffer_load_dwordx4 a[204:207], v1, s[8:11], s76 offen offset:2176 nt
    s_add_u32 m0, s42, 60416
    s_nop 0
    buffer_load_dwordx4 v215, s[44:47], s33 offen nt lds
    s_add_u32 s33, s33, 0x1000
    s_waitcnt vmcnt(9)
    buffer_load_dwordx4 a[208:211], v1, s[8:11], s77 offen offset:0 nt
    s_waitcnt vmcnt(9)
    buffer_load_dwordx4 a[212:215], v1, s[8:11], s77 offen offset:128 nt
    s_waitcnt vmcnt(9)
    buffer_load_dwordx4 a[216:219], v1, s[8:11], s77 offen offset:2048 nt
    s_waitcnt vmcnt(9)
    buffer_load_dwordx4 a[220:223], v1, s[8:11], s77 offen offset:2176 nt
    s_waitcnt vmcnt(9)
    buffer_load_dwordx4 a[224:227], v1, s[8:11], s78 offen offset:0 nt
    s_waitcnt vmcnt(9)
    buffer_load_dwordx4 a[228:231], v1, s[8:11], s78 offen offset:128 nt
    s_waitcnt vmcnt(9)
    buffer_load_dwordx4 a[232:235], v1, s[8:11], s78 offen offset:2048 nt
    s_waitcnt vmcnt(9)
    buffer_load_dwordx4 a[236:239], v1, s[8:11], s78 offen offset:2176 nt
    s_waitcnt vmcnt(9)
    buffer_load_dwordx4 a[240:243], v1, s[8:11], s79 offen offset:0 nt
    s_waitcnt vmcnt(9)
    buffer_load_dwordx4 a[244:247], v1, s[8:11], s79 offen offset:128 nt
    s_waitcnt vmcnt(9)
    buffer_load_dwordx4 a[248:251], v1, s[8:11], s79 offen offset:2048 nt
    s_waitcnt vmcnt(9)
    buffer_load_dwordx4 a[252:255], v1, s[8:11], s79 offen offset:2176 nt
    s_mov_b32 s43, 0x10001
    s_mov_b32 s42, 0x41ff41ff
    s_mov_b32 s62, 0x32003200
    s_mov_b32 s63, 0x10001000
L_pass1:
    buffer_load_dwordx4 v[8:11], v0, s[16:19], s95 offen offset:0 sc1
    buffer_load_dwordx4 v[12:15], v0, s[16:19], s95 offen offset:1024 sc1
    v_mov_b64 v[24:25], 0
    v_mov_b64 v[26:27], 0
    v_mov_b64 v[28:29], 0
    v_mov_b64 v[30:31], 0
    v_mov_b64_e64 v[32:33], 0
    v_mov_b64_e64 v[34:35], 0
    v_mov_b64_e64 v[40:41], 0
    v_mov_b64_e64 v[42:43], 0
    v_add_u32_e64 v36, s30, v0
    s_lshl_b32 s27, s3, 9
    v_lshl_add_u32 v46, v0, 1, s27
    s_waitcnt vmcnt(7)
    s_add_u32 m0, s30, 0
    s_nop 0
    buffer_load_dwordx4 v2, s[12:15], s64 offen offset:0 nt lds
    s_waitcnt vmcnt(7)
    s_add_u32 m0, s30, 1536
    s_nop 0
    buffer_load_dwordx4 v2, s[12:15], s64 offen offset:512 nt lds
    s_waitcnt vmcnt(7)
    s_add_u32 m0, s30, 3072
    s_nop 0
    buffer_load_dwordx4 v2, s[12:15], s64 offen offset:1024 nt lds
    s_waitcnt vmcnt(7)
    s_add_u32 m0, s30, 4608
    s_nop 0
    buffer_load_dwordx4 v2, s[12:15], s64 offen offset:1536 nt lds
    s_waitcnt vmcnt(7)
    s_add_u32 m0, s30, 1024
    s_nop 0
    buffer_load_dwordx4 v2, s[12:15], s65 offen offset:0 nt lds
    s_waitcnt vmcnt(7)
    s_add_u32 m0, s30, 2560
    s_nop 0
    buffer_load_dwordx4 v2, s[12:15], s65 offen offset:512 nt lds
    s_waitcnt vmcnt(7)
    s_add_u32 m0, s30, 4096
    s_nop 0
    buffer_load_dwordx4 v2, s[12:15], s65 offen offset:1024 nt lds
    s_waitcnt vmcnt(7)
    s_add_u32 m0, s30, 5632
    s_nop 0
    buffer_load_dwordx4 v2, s[12:15], s65 offen offset:1536 nt lds
    s_waitcnt vmcnt(8)
    s_branch L_q1c_16
L_q1w_15:
    s_waitcnt vmcnt(0)
L_q1c_16:
    v_max3_u32 v44, v8, v9, v10
    v_max3_u32 v44, v44, v11, v12
    v_max3_u32 v44, v44, v13, v14
    v_max_u32 v44, v44, v15
    v_cmp_eq_u32 vcc, -1, v44
    s_cbranch_vccnz L_q1r_17
    s_add_u32 s95, s95, 0x10000
    v_add_f32_dpp v8, v8, v8 row_ror:4 row_mask:0xf bank_mask:0xf
    v_add_f32_dpp v9, v9, v9 row_ror:4 row_mask:0xf bank_mask:0xf
    v_add_f32_dpp v10, v10, v10 row_ror:4 row_mask:0xf bank_mask:0xf
    v_add_f32_dpp v11, v11, v11 row_ror:4 row_mask:0xf bank_mask:0xf
    v_add_f32_dpp v12, v12, v12 row_ror:4 row_mask:0xf bank_mask:0xf
    v_add_f32_dpp v13, v13, v13 row_ror:4 row_mask:0xf bank_mask:0xf
    v_add_f32_dpp v14, v14, v14 row_ror:4 row_mask:0xf bank_mask:0xf
    v_add_f32_dpp v15, v15, v15 row_ror:4 row_mask:0xf bank_mask:0xf
    v_add_f32_dpp v8, v8, v8 row_ror:8 row_mask:0xf bank_mask:0xf
    v_add_f32_dpp v9, v9, v9 row_ror:8 row_mask:0xf bank_mask:0xf
    s_waitcnt vmcnt(7)
    s_add_u32 m0, s30, 8192
    s_nop 0
    buffer_load_dwordx4 v2, s[12:15], s66 offen offset:0 nt lds
    v_add_f32_dpp v10, v10, v10 row_ror:8 row_mask:0xf bank_mask:0xf
    v_add_f32_dpp v11, v11, v11 row_ror:8 row_mask:0xf bank_mask:0xf
    v_add_f32_dpp v12, v12, v12 row_ror:8 row_mask:0xf bank_mask:0xf
    v_add_f32_dpp v13, v13, v13 row_ror:8 row_mask:0xf bank_mask:0xf
    v_add_f32_dpp v14, v14, v14 row_ror:8 row_mask:0xf bank_mask:0xf
    v_add_f32_dpp v15, v15, v15 row_ror:8 row_mask:0xf bank_mask:0xf
    v_cvt_pk_bf16_f32 v4, v8, v9
    v_cvt_pk_bf16_f32 v5, v10, v11
    v_cvt_pk_bf16_f32 v6, v12, v13
    v_cvt_pk_bf16_f32 v7, v14, v15
    s_waitcnt vmcnt(7)
    s_add_u32 m0, s30, 9728
    s_nop 0
    buffer_load_dwordx4 v2, s[12:15], s66 offen offset:512 nt lds
    v_cndmask_b32 v8, 0, v4, s[80:81]
    v_cndmask_b32 v9, 0, v5, s[80:81]
    v_cndmask_b32 v10, 0, v6, s[80:81]
    v_cndmask_b32 v11, 0, v7, s[80:81]
    v_cndmask_b32 v12, 0, v4, s[82:83]
    v_cndmask_b32 v13, 0, v5, s[82:83]
    v_cndmask_b32 v14, 0, v6, s[82:83]
    v_cndmask_b32 v15, 0, v7, s[82:83]
    v_smfmac_f32_16x16x64_bf16 v[24:27], v[8:11], a[0:7], v3
    v_cndmask_b32 v16, 0, v4, s[84:85]
    s_waitcnt vmcnt(7)
    s_add_u32 m0, s30, 11264
    s_nop 0
    buffer_load_dwordx4 v2, s[12:15], s66 offen offset:1024 nt lds
    v_cndmask_b32 v17, 0, v5, s[84:85]
    v_cndmask_b32 v18, 0, v6, s[84:85]
    v_cndmask_b32 v19, 0, v7, s[84:85]
    v_smfmac_f32_16x16x64_bf16 v[24:27], v[12:15], a[8:15], v3
    v_cndmask_b32 v20, 0, v4, s[86:87]
    v_cndmask_b32 v21, 0, v5, s[86:87]
    v_cndmask_b32 v22, 0, v6, s[86:87]
    v_cndmask_b32 v23, 0, v7, s[86:87]
    v_smfmac_f32_16x16x64_bf16 v[24:27], v[16:19], a[16:23], v3
    s_nop 0
    v_smfmac_f32_16x16x64_bf16 v[24:27], v[20:23], a[24:31], v3
    s_waitcnt vmcnt(7)
    s_add_u32 m0, s30, 12800
    s_nop 0
    buffer_load_dwordx4 v2, s[12:15], s66 offen offset:1536 nt lds
    v_smfmac_f32_16x16x64_bf16 v[28:31], v[8:11], a[32:39], v3
    v_smfmac_f32_16x16x64_bf16 v[28:31], v[12:15], a[40:47], v3
    v_smfmac_f32_16x16x64_bf16 v[28:31], v[16:19], a[48:55], v3
    v_smfmac_f32_16x16x64_bf16 v[28:31], v[20:23], a[56:63], v3
    v_add_f32 v24, v24, v25
    v_add_f32_e64 v26, v26, v27
    v_smfmac_f32_16x16x64_bf16 v[32:35], v[8:11], a[64:71], v3
    v_smfmac_f32_16x16x64_bf16 v[32:35], v[12:15], a[72:79], v3
    v_add_f32_dpp v4, v26, v24 row_ror:8 row_mask:0xf bank_mask:0x3
    v_smfmac_f32_16x16x64_bf16 v[32:35], v[16:19], a[80:87], v3
    s_waitcnt vmcnt(7)
    s_add_u32 m0, s30, 9216
    s_nop 0
    buffer_load_dwordx4 v2, s[12:15], s67 offen offset:0 nt lds
    v_mov_b64 v[24:25], 0
    v_mov_b64 v[26:27], 0
    v_smfmac_f32_16x16x64_bf16 v[32:35], v[20:23], a[88:95], v3
    v_add_f32 v28, v28, v29
    v_add_f32 v30, v30, v31
    v_smfmac_f32_16x16x64_bf16 v[24:27], v[8:11], a[96:103], v3
    v_smfmac_f32_16x16x64_bf16 v[24:27], v[12:15], a[104:111], v3
    v_add_f32_dpp v4, v28, v30 row_ror:8 row_mask:0xf bank_mask:0xc
    v_smfmac_f32_16x16x64_bf16 v[24:27], v[16:19], a[112:119], v3
    v_mov_b64 v[28:29], 0
    s_waitcnt vmcnt(7)
    s_add_u32 m0, s30, 10752
    s_nop 0
    buffer_load_dwordx4 v2, s[12:15], s67 offen offset:512 nt lds
    v_mov_b64 v[30:31], 0
    v_smfmac_f32_16x16x64_bf16 v[24:27], v[20:23], a[120:127], v3
    v_add_f32 v32, v32, v33
    v_add_f32 v34, v34, v35
    v_smfmac_f32_16x16x64_bf16 v[28:31], v[8:11], a[128:135], v3
    v_smfmac_f32_16x16x64_bf16 v[28:31], v[12:15], a[136:143], v3
    v_add_f32_dpp v5, v34, v32 row_ror:8 row_mask:0xf bank_mask:0x3
    v_smfmac_f32_16x16x64_bf16 v[28:31], v[16:19], a[144:151], v3
    v_mov_b64 v[32:33], 0
    v_mov_b64 v[34:35], 0
    s_waitcnt vmcnt(7)
    s_add_u32 m0, s30, 12288
    s_nop 0
    buffer_load_dwordx4 v2, s[12:15], s67 offen offset:1024 nt lds
    v_smfmac_f32_16x16x64_bf16 v[28:31], v[20:23], a[152:159], v3
    v_add_f32 v24, v24, v25
    v_add_f32 v26, v26, v27
    v_smfmac_f32_16x16x64_bf16 v[32:35], v[8:11], a[160:167], v3
    v_smfmac_f32_16x16x64_bf16 v[32:35], v[12:15], a[168:175], v3
    v_add_f32_dpp v5, v24, v26 row_ror:8 row_mask:0xf bank_mask:0xc
    v_smfmac_f32_16x16x64_bf16 v[32:35], v[16:19], a[176:183], v3
    v_mov_b64 v[24:25], 0
    v_mov_b64 v[26:27], 0
    v_smfmac_f32_16x16x64_bf16 v[32:35], v[20:23], a[184:191], v3
    s_waitcnt vmcnt(7)
    s_add_u32 m0, s30, 13824
    s_nop 0
    buffer_load_dwordx4 v2, s[12:15], s67 offen offset:1536 nt lds
    v_add_f32 v28, v28, v29
    v_add_f32 v30, v30, v31
    v_smfmac_f32_16x16x64_bf16 v[24:27], v[8:11], a[192:199], v3
    v_smfmac_f32_16x16x64_bf16 v[24:27], v[12:15], a[200:207], v3
    v_add_f32_dpp v6, v30, v28 row_ror:8 row_mask:0xf bank_mask:0x3
    v_smfmac_f32_16x16x64_bf16 v[24:27], v[16:19], a[208:215], v3
    v_mov_b64 v[28:29], 0
    v_mov_b64 v[30:31], 0
    v_smfmac_f32_16x16x64_bf16 v[24:27], v[20:23], a[216:223], v3
    v_add_f32 v32, v32, v33
    s_waitcnt vmcnt(7)
    buffer_load_dwordx4 v[64:67], v2, s[12:15], s68 offen offset:0 nt
    v_add_f32_e64 v34, v34, v35
    v_smfmac_f32_16x16x64_bf16 v[28:31], v[8:11], a[224:231], v3
    v_smfmac_f32_16x16x64_bf16 v[28:31], v[12:15], a[232:239], v3
    v_add_f32_dpp v6, v32, v34 row_ror:8 row_mask:0xf bank_mask:0xc
    v_smfmac_f32_16x16x64_bf16 v[28:31], v[16:19], a[240:247], v3
    v_smfmac_f32_16x16x64_bf16 v[28:31], v[20:23], a[248:255], v3
    v_add_f32 v24, v24, v25
    v_add_f32 v26, v26, v27
    v_max3_f32 v44, v4, v5, v6
    s_nop 0
    v_add_f32_dpp v7, v26, v24 row_ror:8 row_mask:0xf bank_mask:0x3
    s_waitcnt vmcnt(7)
    buffer_load_dwordx4 v[72:75], v2, s[12:15], s68 offen offset:512 nt
    s_nop 0
    v_add_f32 v28, v28, v29
    v_add_f32 v30, v30, v31
    s_nop 1
    v_add_f32_dpp v7, v28, v30 row_ror:8 row_mask:0xf bank_mask:0xc
    v_max_f32 v44, v44, v7
    v_mov_b64 v[16:17], 0
    v_mov_b64_e64 v[18:19], 0
    v_max_f32_dpp v44, v44, v44 row_ror:1 row_mask:0xf bank_mask:0xf
    s_nop 1
    v_max_f32_dpp v44, v44, v44 row_ror:2 row_mask:0xf bank_mask:0xf
    s_nop 1
    v_max_f32_dpp v44, v44, v44 row_ror:4 row_mask:0xf bank_mask:0xf
    s_nop 1
    v_max_f32_dpp v44, v44, v44 row_ror:8 row_mask:0xf bank_mask:0xf
    s_waitcnt vmcnt(7)
    buffer_load_dwordx4 v[80:83], v2, s[12:15], s68 offen offset:1024 nt
    v_mov_b32 v45, v44
    s_nop 1
    v_permlane16_swap_b32 v45, v44
    v_max_f32 v44, v44, v45
    v_mov_b32 v45, v44
    s_nop 0
    s_nop 0
    v_permlane32_swap_b32 v45, v44
    v_max_f32_e64 v44, v44, v45
    v_mul_f32 v44, s60, v44
    v_fma_f32 v4, v4, s60, -v44
    v_fma_f32 v5, v5, s60, -v44
    v_fma_f32 v6, v6, s60, -v44
    s_waitcnt vmcnt(7)
    buffer_load_dwordx4 v[88:91], v2, s[12:15], s68 offen offset:1536 nt
    v_fma_f32 v7, v7, s60, -v44
    v_exp_f32 v4, v4
    v_exp_f32 v5, v5
    v_exp_f32 v6, v6
    v_exp_f32 v7, v7
    v_add_f32 v45, v4, v5
    v_cvt_pk_bf16_f32 v4, v4, 0
    v_add_f32 v21, v6, v7
    v_cvt_pk_bf16_f32 v20, v6, 0
    v_cvt_pk_bf16_f32 v6, v5, 0
    s_waitcnt vmcnt(7)
    buffer_load_dwordx4 v[68:71], v2, s[12:15], s69 offen offset:0 nt
    v_cvt_pk_bf16_f32 v22, v7, 0
    v_add_f32 v45, v45, v21
    v_mov_b32_dpp v5, v4 quad_perm:[2,3,2,3] row_mask:0xf bank_mask:0xf
    v_mov_b32_dpp v7, v6 quad_perm:[2,3,2,3] row_mask:0xf bank_mask:0xf
    v_mov_b32_dpp v21, v20 quad_perm:[2,3,2,3] row_mask:0xf bank_mask:0xf
    v_mov_b32_dpp v23, v22 quad_perm:[2,3,2,3] row_mask:0xf bank_mask:0xf
    v_add_f32_dpp v45, v45, v45 row_ror:1 row_mask:0xf bank_mask:0xf
    s_nop 0
    s_nop 0
    v_add_f32_dpp v45, v45, v45 row_ror:2 row_mask:0xf bank_mask:0xf
    s_nop 0
    s_nop 0
    v_add_f32_dpp v45, v45, v45 row_ror:4 row_mask:0xf bank_mask:0xf
    s_nop 1
    v_add_f32_dpp v45, v45, v45 row_ror:8 row_mask:0xf bank_mask:0xf
    s_waitcnt vmcnt(7)
    buffer_load_dwordx4 v[76:79], v2, s[12:15], s69 offen offset:512 nt
    v_add_f32_dpp v45, v45, v45 row_bcast:15 row_mask:0xa bank_mask:0xf
    s_nop 1
    v_add_f32_dpp v45, v45, v45 row_bcast:31 row_mask:0xc bank_mask:0xf
    s_waitcnt vmcnt(7)
    buffer_load_dwordx4 v[84:87], v2, s[12:15], s69 offen offset:1024 nt
    v_mov_b64_dpp v[8:9], v[4:5] row_newbcast:0 row_mask:0xf bank_mask:0xf
    v_mov_b64_dpp v[10:11], v[4:5] row_newbcast:1 row_mask:0xf bank_mask:0xf
    ds_read_b128 v[48:51], v36 offset:0
    ds_read_b128 v[52:55], v36 offset:1024
    ds_read_b128 v[56:59], v36 offset:2048
    ds_read_b128 v[60:63], v36 offset:3072
    s_waitcnt lgkmcnt(0)
    v_swap_b32 v50, v56
    v_swap_b32 v51, v57
    v_swap_b32 v54, v60
    v_swap_b32 v55, v61
    s_nop 1
    v_smfmac_f32_16x16x64_bf16 v[40:43], v[8:11], v[48:55], v3 abid:1
    v_smfmac_f32_16x16x64_bf16 v[16:19], v[8:11], v[56:63], v3 abid:1
    ds_write_b128 v36, v[48:51] offset:0
    ds_write_b128 v36, v[52:55] offset:1024
    ds_write_b128 v36, v[56:59] offset:2048
    ds_write_b128 v36, v[60:63] offset:3072
    s_waitcnt lgkmcnt(0)
    s_waitcnt vmcnt(7)
    buffer_load_dwordx4 v[92:95], v2, s[12:15], s69 offen offset:1536 nt
    s_barrier
    v_mov_b64_dpp v[12:13], v[4:5] row_newbcast:4 row_mask:0xf bank_mask:0xf
    v_mov_b64_dpp v[14:15], v[4:5] row_newbcast:5 row_mask:0xf bank_mask:0xf
    ds_read_b128 v[48:51], v36 offset:4096
    ds_read_b128 v[52:55], v36 offset:5120
    ds_read_b128 v[56:59], v36 offset:6144
    ds_read_b128 v[60:63], v36 offset:7168
    s_waitcnt lgkmcnt(0)
    v_swap_b32 v50, v56
    v_swap_b32 v51, v57
    v_swap_b32 v54, v60
    v_swap_b32 v55, v61
    s_nop 0
    s_nop 0
    v_smfmac_f32_16x16x64_bf16 v[40:43], v[12:15], v[48:55], v3 abid:1
    v_smfmac_f32_16x16x64_bf16 v[16:19], v[12:15], v[56:63], v3 abid:1
    ds_write_b128 v36, v[48:51] offset:4096
    ds_write_b128 v36, v[52:55] offset:5120
    ds_write_b128 v36, v[56:59] offset:6144
    ds_write_b128 v36, v[60:63] offset:7168
    s_waitcnt lgkmcnt(0)
    s_waitcnt vmcnt(7)
    buffer_load_dwordx4 v[96:99], v2, s[12:15], s70 offen offset:0 nt
    v_mov_b64_dpp v[8:9], v[4:5] row_newbcast:8 row_mask:0xf bank_mask:0xf
    v_mov_b64_dpp v[10:11], v[4:5] row_newbcast:9 row_mask:0xf bank_mask:0xf
    ds_read_b128 v[48:51], v36 offset:8192
    ds_read_b128 v[52:55], v36 offset:9216
    ds_read_b128 v[56:59], v36 offset:10240
    ds_read_b128 v[60:63], v36 offset:11264
    s_waitcnt lgkmcnt(0)
    v_swap_b32 v50, v56
    v_swap_b32 v51, v57
    v_swap_b32 v54, v60
    v_swap_b32 v55, v61
    s_nop 1
    v_smfmac_f32_16x16x64_bf16 v[40:43], v[8:11], v[48:55], v3 abid:1
    v_smfmac_f32_16x16x64_bf16 v[16:19], v[8:11], v[56:63], v3 abid:1
    ds_write_b128 v36, v[48:51] offset:8192
    ds_write_b128 v36, v[52:55] offset:9216
    ds_write_b128 v36, v[56:59] offset:10240
    ds_write_b128 v36, v[60:63] offset:11264
    s_waitcnt lgkmcnt(0)
    s_waitcnt vmcnt(7)
    buffer_load_dwordx4 v[104:107], v2, s[12:15], s70 offen offset:512 nt
    v_mov_b64_dpp v[12:13], v[4:5] row_newbcast:12 row_mask:0xf bank_mask:0xf
    v_mov_b64_dpp v[14:15], v[4:5] row_newbcast:13 row_mask:0xf bank_mask:0xf
    ds_read_b128 v[48:51], v36 offset:12288
    ds_read_b128 v[52:55], v36 offset:13312
    ds_read_b128 v[56:59], v36 offset:14336
    ds_read_b128 v[60:63], v36 offset:15360
    s_waitcnt lgkmcnt(0)
    v_swap_b32 v50, v56
    v_swap_b32 v51, v57
    v_swap_b32 v54, v60
    v_swap_b32 v55, v61
    s_nop 1
    v_smfmac_f32_16x16x64_bf16 v[40:43], v[12:15], v[48:55], v3 abid:1
    v_smfmac_f32_16x16x64_bf16 v[16:19], v[12:15], v[56:63], v3 abid:1
    ds_write_b128 v36, v[48:51] offset:12288
    ds_write_b128 v36, v[52:55] offset:13312
    ds_write_b128 v36, v[56:59] offset:14336
    ds_write_b128 v36, v[60:63] offset:15360
    s_waitcnt lgkmcnt(0)
    s_waitcnt vmcnt(7)
    buffer_load_dwordx4 v[112:115], v2, s[12:15], s70 offen offset:1024 nt
    s_waitcnt vmcnt(7)
    buffer_load_dwordx4 v[120:123], v2, s[12:15], s70 offen offset:1536 nt
    s_barrier
    s_waitcnt vmcnt(7)
    buffer_load_dwordx4 v[100:103], v2, s[12:15], s71 offen offset:0 nt
    s_waitcnt vmcnt(7)
    buffer_load_dwordx4 v[108:111], v2, s[12:15], s71 offen offset:512 nt
    v_mov_b64_dpp v[8:9], v[6:7] row_newbcast:0 row_mask:0xf bank_mask:0xf
    v_mov_b64_dpp v[10:11], v[6:7] row_newbcast:1 row_mask:0xf bank_mask:0xf
    v_swap_b32 v66, v72
    v_swap_b32 v67, v73
    v_swap_b32 v70, v76
    v_swap_b32 v71, v77
    s_nop 1
    v_smfmac_f32_16x16x64_bf16 v[40:43], v[8:11], v[64:71], v3 abid:1
    v_smfmac_f32_16x16x64_bf16 v[16:19], v[8:11], v[72:79], v3 abid:1
    s_waitcnt vmcnt(7)
    buffer_load_dwordx4 v[116:119], v2, s[12:15], s71 offen offset:1024 nt
    s_waitcnt vmcnt(7)
    buffer_load_dwordx4 v[124:127], v2, s[12:15], s71 offen offset:1536 nt
    s_barrier
    v_mov_b64_dpp v[12:13], v[6:7] row_newbcast:4 row_mask:0xf bank_mask:0xf
    v_mov_b64_dpp v[14:15], v[6:7] row_newbcast:5 row_mask:0xf bank_mask:0xf
    v_swap_b32 v82, v88
    v_swap_b32 v83, v89
    v_swap_b32 v86, v92
    v_swap_b32 v87, v93
    s_nop 0
    s_nop 0
    v_smfmac_f32_16x16x64_bf16 v[40:43], v[12:15], v[80:87], v3 abid:1
    v_smfmac_f32_16x16x64_bf16 v[16:19], v[12:15], v[88:95], v3 abid:1
    s_waitcnt vmcnt(7)
    buffer_load_dwordx4 v[128:131], v2, s[12:15], s72 offen offset:0 nt
    s_waitcnt vmcnt(7)
    buffer_load_dwordx4 v[136:139], v2, s[12:15], s72 offen offset:512 nt
    s_waitcnt vmcnt(7)
    buffer_load_dwordx4 v[144:147], v2, s[12:15], s72 offen offset:1024 nt
    s_waitcnt vmcnt(7)
    buffer_load_dwordx4 v[152:155], v2, s[12:15], s72 offen offset:1536 nt
    s_cmp_eq_u32 s24, 0
    s_cbranch_scc1 L_tb0h_19
L_tb0b_20:
    s_barrier
    s_waitcnt vmcnt(7)
    buffer_load_dwordx4 v[132:135], v2, s[12:15], s73 offen offset:0 nt
    s_waitcnt vmcnt(7)
    buffer_load_dwordx4 v[140:143], v2, s[12:15], s73 offen offset:512 nt
    v_mov_b64_dpp v[8:9], v[6:7] row_newbcast:8 row_mask:0xf bank_mask:0xf
    v_mov_b64_dpp v[10:11], v[6:7] row_newbcast:9 row_mask:0xf bank_mask:0xf
    v_swap_b32 v98, v104
    v_swap_b32 v99, v105
    v_swap_b32 v102, v108
    v_swap_b32 v103, v109
    s_nop 0
    s_nop 0
    v_smfmac_f32_16x16x64_bf16 v[40:43], v[8:11], v[96:103], v3 abid:1
    v_smfmac_f32_16x16x64_bf16 v[16:19], v[8:11], v[104:111], v3 abid:1
    s_waitcnt vmcnt(7)
    buffer_load_dwordx4 v[148:151], v2, s[12:15], s73 offen offset:1024 nt
    s_waitcnt vmcnt(7)
    buffer_load_dwordx4 v[156:159], v2, s[12:15], s73 offen offset:1536 nt
    s_barrier
    v_mov_b64_dpp v[12:13], v[6:7] row_newbcast:12 row_mask:0xf bank_mask:0xf
    v_mov_b64_dpp v[14:15], v[6:7] row_newbcast:13 row_mask:0xf bank_mask:0xf
    v_swap_b32 v114, v120
    v_swap_b32 v115, v121
    v_swap_b32 v118, v124
    v_swap_b32 v119, v125
    s_nop 0
    s_nop 0
    v_smfmac_f32_16x16x64_bf16 v[40:43], v[12:15], v[112:119], v3 abid:1
    v_smfmac_f32_16x16x64_bf16 v[16:19], v[12:15], v[120:127], v3 abid:1
    s_waitcnt vmcnt(7)
    buffer_load_dwordx4 v[160:163], v2, s[12:15], s74 offen offset:0 nt
    s_waitcnt vmcnt(7)
    buffer_load_dwordx4 v[168:171], v2, s[12:15], s74 offen offset:512 nt
    s_waitcnt vmcnt(7)
    buffer_load_dwordx4 v[176:179], v2, s[12:15], s74 offen offset:1024 nt
    s_waitcnt vmcnt(7)
    buffer_load_dwordx4 v[184:187], v2, s[12:15], s74 offen offset:1536 nt
    s_barrier
    s_waitcnt vmcnt(7)
    buffer_load_dwordx4 v[164:167], v2, s[12:15], s75 offen offset:0 nt
    s_cmp_eq_u32 s24, 0
    s_cbranch_scc1 L_tb1h_21
L_tb1b_22:
    s_waitcnt vmcnt(7)
    buffer_load_dwordx4 v[172:175], v2, s[12:15], s75 offen offset:512 nt
    v_mov_b64_dpp v[8:9], v[20:21] row_newbcast:0 row_mask:0xf bank_mask:0xf
    v_mov_b64_dpp v[10:11], v[20:21] row_newbcast:1 row_mask:0xf bank_mask:0xf
    v_swap_b32 v130, v136
    v_swap_b32 v131, v137
    v_swap_b32 v134, v140
    v_swap_b32 v135, v141
    s_nop 0
    s_nop 0
    v_smfmac_f32_16x16x64_bf16 v[40:43], v[8:11], v[128:135], v3 abid:1
    v_smfmac_f32_16x16x64_bf16 v[16:19], v[8:11], v[136:143], v3 abid:1
    s_waitcnt vmcnt(7)
    buffer_load_dwordx4 v[180:183], v2, s[12:15], s75 offen offset:1024 nt
    s_waitcnt vmcnt(7)
    buffer_load_dwordx4 v[188:191], v2, s[12:15], s75 offen offset:1536 nt
    s_barrier
    v_mov_b64_dpp v[12:13], v[20:21] row_newbcast:4 row_mask:0xf bank_mask:0xf
    v_mov_b64_dpp v[14:15], v[20:21] row_newbcast:5 row_mask:0xf bank_mask:0xf
    v_swap_b32 v146, v152
    v_swap_b32 v147, v153
    v_swap_b32 v150, v156
    v_swap_b32 v151, v157
    s_nop 0
    s_nop 0
    v_smfmac_f32_16x16x64_bf16 v[40:43], v[12:15], v[144:151], v3 abid:1
    v_smfmac_f32_16x16x64_bf16 v[16:19], v[12:15], v[152:159], v3 abid:1
    s_waitcnt vmcnt(7)
    buffer_load_dwordx4 v[192:195], v2, s[12:15], s76 offen offset:0 nt
    s_waitcnt vmcnt(7)
    buffer_load_dwordx4 v[200:203], v2, s[12:15], s76 offen offset:512 nt
    s_waitcnt vmcnt(7)
    buffer_load_dwordx4 v[208:211], v2, s[12:15], s76 offen offset:1024 nt
    s_waitcnt vmcnt(7)
    buffer_load_dwordx4 v[216:219], v2, s[12:15], s76 offen offset:1536 nt
    s_barrier
    s_waitcnt vmcnt(7)
    buffer_load_dwordx4 v[196:199], v2, s[12:15], s77 offen offset:0 nt
    s_waitcnt vmcnt(7)
    buffer_load_dwordx4 v[204:207], v2, s[12:15], s77 offen offset:512 nt
    s_cmp_eq_u32 s24, 0
    s_cbranch_scc1 L_tb2h_23
L_tb2b_24:
    v_mov_b64_dpp v[8:9], v[20:21] row_newbcast:8 row_mask:0xf bank_mask:0xf
    v_mov_b64_dpp v[10:11], v[20:21] row_newbcast:9 row_mask:0xf bank_mask:0xf
    v_swap_b32 v162, v168
    v_swap_b32 v163, v169
    v_swap_b32 v166, v172
    v_swap_b32 v167, v173
    s_nop 0
    s_nop 0
    v_smfmac_f32_16x16x64_bf16 v[40:43], v[8:11], v[160:167], v3 abid:1
    v_smfmac_f32_16x16x64_bf16 v[16:19], v[8:11], v[168:175], v3 abid:1
    s_waitcnt vmcnt(7)
    buffer_load_dwordx4 v[212:215], v2, s[12:15], s77 offen offset:1024 nt
    s_waitcnt vmcnt(7)
    buffer_load_dwordx4 v[220:223], v2, s[12:15], s77 offen offset:1536 nt
    s_barrier
    v_mov_b64_dpp v[12:13], v[20:21] row_newbcast:12 row_mask:0xf bank_mask:0xf
    v_mov_b64_dpp v[14:15], v[20:21] row_newbcast:13 row_mask:0xf bank_mask:0xf
    v_swap_b32 v178, v184
    v_swap_b32 v179, v185
    v_swap_b32 v182, v188
    v_swap_b32 v183, v189
    s_nop 0
    s_nop 0
    v_smfmac_f32_16x16x64_bf16 v[40:43], v[12:15], v[176:183], v3 abid:1
    v_smfmac_f32_16x16x64_bf16 v[16:19], v[12:15], v[184:191], v3 abid:1
    s_waitcnt vmcnt(7)
    buffer_load_dwordx4 v[224:227], v2, s[12:15], s78 offen offset:0 nt
    s_waitcnt vmcnt(7)
    buffer_load_dwordx4 v[232:235], v2, s[12:15], s78 offen offset:512 nt
    s_waitcnt vmcnt(7)
    buffer_load_dwordx4 v[240:243], v2, s[12:15], s78 offen offset:1024 nt
    s_waitcnt vmcnt(7)
    buffer_load_dwordx4 v[248:251], v2, s[12:15], s78 offen offset:1536 nt
    s_barrier
    s_waitcnt vmcnt(7)
    buffer_load_dwordx4 v[228:231], v2, s[12:15], s79 offen offset:0 nt
    s_waitcnt vmcnt(7)
    buffer_load_dwordx4 v[236:239], v2, s[12:15], s79 offen offset:512 nt
    v_mov_b64_dpp v[8:9], v[22:23] row_newbcast:0 row_mask:0xf bank_mask:0xf
    v_mov_b64_dpp v[10:11], v[22:23] row_newbcast:1 row_mask:0xf bank_mask:0xf
    v_swap_b32 v194, v200
    v_swap_b32 v195, v201
    v_swap_b32 v198, v204
    v_swap_b32 v199, v205
    s_nop 1
    v_smfmac_f32_16x16x64_bf16 v[40:43], v[8:11], v[192:199], v3 abid:1
    v_smfmac_f32_16x16x64_bf16 v[16:19], v[8:11], v[200:207], v3 abid:1
    s_waitcnt vmcnt(7)
    buffer_load_dwordx4 v[244:247], v2, s[12:15], s79 offen offset:1024 nt
    s_waitcnt vmcnt(7)
    buffer_load_dwordx4 v[252:255], v2, s[12:15], s79 offen offset:1536 nt
    s_barrier
    v_mov_b64_dpp v[12:13], v[22:23] row_newbcast:4 row_mask:0xf bank_mask:0xf
    v_mov_b64_dpp v[14:15], v[22:23] row_newbcast:5 row_mask:0xf bank_mask:0xf
    v_swap_b32 v210, v216
    v_swap_b32 v211, v217
    v_swap_b32 v214, v220
    v_swap_b32 v215, v221
    s_nop 1
    v_smfmac_f32_16x16x64_bf16 v[40:43], v[12:15], v[208:215], v3 abid:1
    v_smfmac_f32_16x16x64_bf16 v[16:19], v[12:15], v[216:223], v3 abid:1
    s_add_u32 s64, s64, 0x4000000
    s_add_u32 s65, s65, 0x4000000
    s_add_u32 s66, s66, 0x4000000
    s_add_u32 s67, s67, 0x4000000
    s_add_u32 s68, s68, 0x4000000
    s_add_u32 s69, s69, 0x4000000
    s_add_u32 s70, s70, 0x4000000
    s_add_u32 s71, s71, 0x4000000
    s_add_u32 s72, s72, 0x4000000
    s_add_u32 s73, s73, 0x4000000
    s_add_u32 s74, s74, 0x4000000
    s_add_u32 s75, s75, 0x4000000
    s_add_u32 s76, s76, 0x4000000
    s_add_u32 s77, s77, 0x4000000
    s_add_u32 s78, s78, 0x4000000
    s_add_u32 s79, s79, 0x4000000
    v_mov_b64_dpp v[8:9], v[22:23] row_newbcast:8 row_mask:0xf bank_mask:0xf
    v_mov_b64_dpp v[10:11], v[22:23] row_newbcast:9 row_mask:0xf bank_mask:0xf
    s_waitcnt vmcnt(2)
    v_swap_b32 v226, v232
    v_swap_b32 v227, v233
    v_swap_b32 v230, v236
    v_swap_b32 v231, v237
    s_nop 1
    v_smfmac_f32_16x16x64_bf16 v[40:43], v[8:11], v[224:231], v3 abid:1
    v_smfmac_f32_16x16x64_bf16 v[16:19], v[8:11], v[232:239], v3 abid:1
    v_mov_b64_dpp v[12:13], v[22:23] row_newbcast:12 row_mask:0xf bank_mask:0xf
    v_mov_b64_dpp v[14:15], v[22:23] row_newbcast:13 row_mask:0xf bank_mask:0xf
    s_waitcnt vmcnt(0)
    v_swap_b32 v242, v248
    v_swap_b32 v243, v249
    v_swap_b32 v246, v252
    v_swap_b32 v247, v253
    s_nop 0
    s_nop 0
    v_smfmac_f32_16x16x64_bf16 v[40:43], v[12:15], v[240:247], v3 abid:1
    v_smfmac_f32_16x16x64_bf16 v[16:19], v[12:15], v[248:255], v3 abid:1
    s_branch L_chain
L_pass2:
    v_cndmask_b32 v12, 0, v4, s[82:83]
    v_cndmask_b32 v13, 0, v5, s[82:83]
    v_cndmask_b32 v14, 0, v6, s[82:83]
    v_cndmask_b32 v15, 0, v7, s[82:83]
    v_smfmac_f32_16x16x64_bf16 v[24:27], v[8:11], a[0:7], v3
    v_cndmask_b32 v16, 0, v4, s[84:85]
    v_cndmask_b32 v17, 0, v5, s[84:85]
    v_cndmask_b32 v18, 0, v6, s[84:85]
    v_cndmask_b32 v19, 0, v7, s[84:85]
    v_smfmac_f32_16x16x64_bf16 v[24:27], v[12:15], a[8:15], v3
    v_cndmask_b32 v20, 0, v4, s[86:87]
    v_cndmask_b32 v21, 0, v5, s[86:87]
    v_cndmask_b32 v22, 0, v6, s[86:87]
    v_cndmask_b32 v23, 0, v7, s[86:87]
    v_smfmac_f32_16x16x64_bf16 v[24:27], v[16:19], a[16:23], v3
    s_nop 0
    v_smfmac_f32_16x16x64_bf16 v[24:27], v[20:23], a[24:31], v3
    v_smfmac_f32_16x16x64_bf16 v[28:31], v[8:11], a[32:39], v3
    v_smfmac_f32_16x16x64_bf16 v[28:31], v[12:15], a[40:47], v3
    v_smfmac_f32_16x16x64_bf16 v[28:31], v[16:19], a[48:55], v3
    v_smfmac_f32_16x16x64_bf16 v[28:31], v[20:23], a[56:63], v3
    s_nop 3
    v_add_f32 v24, v24, v25
    v_add_f32 v26, v26, v27
    v_smfmac_f32_16x16x64_bf16 v[32:35], v[8:11], a[64:71], v3
    s_cmp_eq_u32 s24, 1
    s_cbranch_scc1 L_hqh_25
L_hqb_26:
    v_smfmac_f32_16x16x64_bf16 v[32:35], v[12:15], a[72:79], v3
    v_add_f32_dpp v4, v26, v24 row_ror:8 row_mask:0xf bank_mask:0x3
    v_smfmac_f32_16x16x64_bf16 v[32:35], v[16:19], a[80:87], v3
    v_mov_b64 v[24:25], 0
    v_mov_b64 v[26:27], 0
    v_smfmac_f32_16x16x64_bf16 v[32:35], v[20:23], a[88:95], v3
    v_add_f32 v28, v28, v29
    v_add_f32 v30, v30, v31
    v_smfmac_f32_16x16x64_bf16 v[24:27], v[8:11], a[96:103], v3
    v_smfmac_f32_16x16x64_bf16 v[24:27], v[12:15], a[104:111], v3
    v_add_f32_dpp v4, v28, v30 row_ror:8 row_mask:0xf bank_mask:0xc
    v_smfmac_f32_16x16x64_bf16 v[24:27], v[16:19], a[112:119], v3
    v_mov_b64 v[28:29], 0
    v_mov_b64 v[30:31], 0
    v_smfmac_f32_16x16x64_bf16 v[24:27], v[20:23], a[120:127], v3
    v_add_f32 v32, v32, v33
    v_add_f32 v34, v34, v35
    v_smfmac_f32_16x16x64_bf16 v[28:31], v[8:11], a[128:135], v3
    v_smfmac_f32_16x16x64_bf16 v[28:31], v[12:15], a[136:143], v3
    v_add_f32_dpp v5, v34, v32 row_ror:8 row_mask:0xf bank_mask:0x3
    v_smfmac_f32_16x16x64_bf16 v[28:31], v[16:19], a[144:151], v3
    v_mov_b64 v[32:33], 0
    v_mov_b64 v[34:35], 0
    v_smfmac_f32_16x16x64_bf16 v[28:31], v[20:23], a[152:159], v3
    v_add_f32 v24, v24, v25
    v_add_f32 v26, v26, v27
    v_smfmac_f32_16x16x64_bf16 v[32:35], v[8:11], a[160:167], v3
    v_smfmac_f32_16x16x64_bf16 v[32:35], v[12:15], a[168:175], v3
    v_add_f32_dpp v5, v24, v26 row_ror:8 row_mask:0xf bank_mask:0xc
    v_smfmac_f32_16x16x64_bf16 v[32:35], v[16:19], a[176:183], v3
    v_mov_b64 v[24:25], 0
    v_mov_b64 v[26:27], 0
    v_smfmac_f32_16x16x64_bf16 v[32:35], v[20:23], a[184:191], v3
    v_add_f32 v28, v28, v29
    v_add_f32 v30, v30, v31
    v_smfmac_f32_16x16x64_bf16 v[24:27], v[8:11], a[192:199], v3
    v_smfmac_f32_16x16x64_bf16 v[24:27], v[12:15], a[200:207], v3
    v_add_f32_dpp v6, v30, v28 row_ror:8 row_mask:0xf bank_mask:0x3
    v_smfmac_f32_16x16x64_bf16 v[24:27], v[16:19], a[208:215], v3
    v_mov_b64 v[28:29], 0
    v_mov_b64 v[30:31], 0
    v_smfmac_f32_16x16x64_bf16 v[24:27], v[20:23], a[216:223], v3
    v_add_f32 v32, v32, v33
    v_add_f32 v34, v34, v35
    v_smfmac_f32_16x16x64_bf16 v[28:31], v[8:11], a[224:231], v3
    v_smfmac_f32_16x16x64_bf16 v[28:31], v[12:15], a[232:239], v3
    v_add_f32_dpp v6, v32, v34 row_ror:8 row_mask:0xf bank_mask:0xc
    v_smfmac_f32_16x16x64_bf16 v[28:31], v[16:19], a[240:247], v3
    v_smfmac_f32_16x16x64_bf16 v[28:31], v[20:23], a[248:255], v3
    s_nop 0
    v_add_f32 v24, v24, v25
    v_add_f32_e64 v26, v26, v27
    s_cmp_eq_u32 s24, 1
    s_cbranch_scc1 L_hph_27
L_hpb_28:
    v_max3_f32 v44, v4, v5, v6
    v_add_f32_dpp v7, v26, v24 row_ror:8 row_mask:0xf bank_mask:0x3
    ds_read_b128 a[192:195], v36 offset:0
    ds_read_b128 a[196:199], v36 offset:1024
    ds_read_b128 a[200:203], v36 offset:2048
    ds_read_b128 a[204:207], v36 offset:3072
    v_add_f32 v28, v28, v29
    v_add_f32 v30, v30, v31
    ds_read_b128 a[208:211], v36 offset:4096
    ds_read_b128 a[212:215], v36 offset:5120
    v_add_f32_dpp v7, v28, v30 row_ror:8 row_mask:0xf bank_mask:0xc
    v_max_f32_e64 v44, v44, v7
    ds_read_b128 a[216:219], v36 offset:6144
    ds_read_b128 a[220:223], v36 offset:7168
    v_max_f32_dpp v44, v44, v44 row_ror:1 row_mask:0xf bank_mask:0xf
    ds_read_b128 a[224:227], v36 offset:8192
    ds_read_b128 a[228:231], v36 offset:9216
    v_max_f32_dpp v44, v44, v44 row_ror:2 row_mask:0xf bank_mask:0xf
    ds_read_b128 a[232:235], v36 offset:10240
    ds_read_b128 a[236:239], v36 offset:11264
    v_max_f32_dpp v44, v44, v44 row_ror:4 row_mask:0xf bank_mask:0xf
    ds_read_b128 a[240:243], v36 offset:12288
    ds_read_b128 a[244:247], v36 offset:13312
    v_max_f32_dpp v44, v44, v44 row_ror:8 row_mask:0xf bank_mask:0xf
    v_mov_b32 v45, v44
    ds_read_b128 a[248:251], v36 offset:14336
    ds_read_b128 a[252:255], v36 offset:15360
    v_permlane16_swap_b32 v45, v44
    v_max_f32 v44, v44, v45
    v_mov_b32 v45, v44
    v_mov_b64 v[16:17], 0
    v_mov_b64 v[18:19], 0
    v_permlane32_swap_b32 v45, v44
    v_max_f32 v44, v44, v45
    v_mul_f32_e64 v44, s60, v44
    v_fma_f32 v4, v4, s60, -v44
    v_fma_f32 v5, v5, s60, -v44
    v_fma_f32 v6, v6, s60, -v44
    v_fma_f32 v7, v7, s60, -v44
    v_exp_f32 v4, v4
    v_exp_f32 v5, v5
    v_exp_f32 v6, v6
    v_exp_f32 v7, v7
    v_add_f32 v45, v4, v5
    v_cvt_pk_bf16_f32 v4, v4, 0
    v_add_f32 v21, v6, v7
    v_cvt_pk_bf16_f32 v20, v6, 0
    v_cvt_pk_bf16_f32 v6, v5, 0
    v_cvt_pk_bf16_f32 v22, v7, 0
    v_add_f32_e64 v45, v45, v21
    v_mov_b32_dpp v5, v4 quad_perm:[2,3,2,3] row_mask:0xf bank_mask:0xf
    v_mov_b32_dpp v7, v6 quad_perm:[2,3,2,3] row_mask:0xf bank_mask:0xf
    v_mov_b32_dpp v21, v20 quad_perm:[2,3,2,3] row_mask:0xf bank_mask:0xf
    v_mov_b32_dpp v23, v22 quad_perm:[2,3,2,3] row_mask:0xf bank_mask:0xf
    v_mov_b64_dpp v[8:9], v[6:7] row_newbcast:0 row_mask:0xf bank_mask:0xf
    v_mov_b64_dpp v[10:11], v[6:7] row_newbcast:1 row_mask:0xf bank_mask:0xf
    v_mov_b64_dpp v[12:13], v[6:7] row_newbcast:4 row_mask:0xf bank_mask:0xf
    v_add_f32_dpp v45, v45, v45 row_ror:1 row_mask:0xf bank_mask:0xf
    v_smfmac_f32_16x16x64_bf16 v[40:43], v[8:11], v[64:71], v3 abid:1
    v_mov_b64_dpp v[14:15], v[6:7] row_newbcast:5 row_mask:0xf bank_mask:0xf
    v_smfmac_f32_16x16x64_bf16 v[16:19], v[8:11], v[72:79], v3 abid:1
    v_mov_b64_dpp v[8:9], v[6:7] row_newbcast:8 row_mask:0xf bank_mask:0xf
    v_add_f32_dpp v45, v45, v45 row_ror:2 row_mask:0xf bank_mask:0xf
    v_smfmac_f32_16x16x64_bf16 v[40:43], v[12:15], v[80:87], v3 abid:1
    v_mov_b64_dpp v[10:11], v[6:7] row_newbcast:9 row_mask:0xf bank_mask:0xf
    v_smfmac_f32_16x16x64_bf16 v[16:19], v[12:15], v[88:95], v3 abid:1
    v_mov_b64_dpp v[12:13], v[6:7] row_newbcast:12 row_mask:0xf bank_mask:0xf
    v_add_f32_dpp v45, v45, v45 row_ror:4 row_mask:0xf bank_mask:0xf
    v_smfmac_f32_16x16x64_bf16 v[40:43], v[8:11], v[96:103], v3 abid:1
    v_mov_b64_dpp v[14:15], v[6:7] row_newbcast:13 row_mask:0xf bank_mask:0xf
    v_smfmac_f32_16x16x64_bf16 v[16:19], v[8:11], v[104:111], v3 abid:1
    v_mov_b64_dpp v[8:9], v[20:21] row_newbcast:0 row_mask:0xf bank_mask:0xf
    v_add_f32_dpp v45, v45, v45 row_ror:8 row_mask:0xf bank_mask:0xf
    v_smfmac_f32_16x16x64_bf16 v[40:43], v[12:15], v[112:119], v3 abid:1
    v_mov_b64_dpp v[10:11], v[20:21] row_newbcast:1 row_mask:0xf bank_mask:0xf
    v_smfmac_f32_16x16x64_bf16 v[16:19], v[12:15], v[120:127], v3 abid:1
    v_mov_b64_dpp v[12:13], v[20:21] row_newbcast:4 row_mask:0xf bank_mask:0xf
    v_add_f32_dpp v45, v45, v45 row_bcast:15 row_mask:0xa bank_mask:0xf
    v_smfmac_f32_16x16x64_bf16 v[40:43], v[8:11], v[128:135], v3 abid:1
    v_mov_b64_dpp v[14:15], v[20:21] row_newbcast:5 row_mask:0xf bank_mask:0xf
    v_smfmac_f32_16x16x64_bf16 v[16:19], v[8:11], v[136:143], v3 abid:1
    v_mov_b64_dpp v[8:9], v[20:21] row_newbcast:8 row_mask:0xf bank_mask:0xf
    v_add_f32_dpp v45, v45, v45 row_bcast:31 row_mask:0xc bank_mask:0xf
    v_smfmac_f32_16x16x64_bf16 v[40:43], v[12:15], v[144:151], v3 abid:1
    v_mov_b64_dpp v[10:11], v[20:21] row_newbcast:9 row_mask:0xf bank_mask:0xf
    v_smfmac_f32_16x16x64_bf16 v[16:19], v[12:15], v[152:159], v3 abid:1
    v_mov_b64_dpp v[12:13], v[20:21] row_newbcast:12 row_mask:0xf bank_mask:0xf
    v_smfmac_f32_16x16x64_bf16 v[40:43], v[8:11], v[160:167], v3 abid:1
    v_mov_b64_dpp v[14:15], v[20:21] row_newbcast:13 row_mask:0xf bank_mask:0xf
    v_smfmac_f32_16x16x64_bf16 v[16:19], v[8:11], v[168:175], v3 abid:1
    v_mov_b64_dpp v[8:9], v[22:23] row_newbcast:0 row_mask:0xf bank_mask:0xf
    v_smfmac_f32_16x16x64_bf16 v[40:43], v[12:15], v[176:183], v3 abid:1
    v_mov_b64_dpp v[10:11], v[22:23] row_newbcast:1 row_mask:0xf bank_mask:0xf
    v_smfmac_f32_16x16x64_bf16 v[16:19], v[12:15], v[184:191], v3 abid:1
    v_mov_b64_dpp v[12:13], v[22:23] row_newbcast:4 row_mask:0xf bank_mask:0xf
    s_cmp_eq_u32 s24, 1
    s_cbranch_scc1 L_hmh_29
L_hmb_30:
    v_smfmac_f32_16x16x64_bf16 v[40:43], v[8:11], v[192:199], v3 abid:1
    v_mov_b64_dpp v[14:15], v[22:23] row_newbcast:5 row_mask:0xf bank_mask:0xf
    v_smfmac_f32_16x16x64_bf16 v[16:19], v[8:11], v[200:207], v3 abid:1
    v_mov_b64_dpp v[8:9], v[22:23] row_newbcast:8 row_mask:0xf bank_mask:0xf
    v_smfmac_f32_16x16x64_bf16 v[40:43], v[12:15], v[208:215], v3 abid:1
    v_mov_b64_dpp v[10:11], v[22:23] row_newbcast:9 row_mask:0xf bank_mask:0xf
    v_smfmac_f32_16x16x64_bf16 v[16:19], v[12:15], v[216:223], v3 abid:1
    v_mov_b64_dpp v[12:13], v[22:23] row_newbcast:12 row_mask:0xf bank_mask:0xf
    v_smfmac_f32_16x16x64_bf16 v[40:43], v[8:11], v[224:231], v3 abid:1
    v_mov_b64_dpp v[14:15], v[22:23] row_newbcast:13 row_mask:0xf bank_mask:0xf
    v_smfmac_f32_16x16x64_bf16 v[16:19], v[8:11], v[232:239], v3 abid:1
    v_mov_b64_dpp v[8:9], v[4:5] row_newbcast:0 row_mask:0xf bank_mask:0xf
    v_smfmac_f32_16x16x64_bf16 v[40:43], v[12:15], v[240:247], v3 abid:1
    v_mov_b64_dpp v[10:11], v[4:5] row_newbcast:1 row_mask:0xf bank_mask:0xf
    v_smfmac_f32_16x16x64_bf16 v[16:19], v[12:15], v[248:255], v3 abid:1
    v_mov_b64_dpp v[12:13], v[4:5] row_newbcast:4 row_mask:0xf bank_mask:0xf
    s_waitcnt lgkmcnt(0)
    v_smfmac_f32_16x16x64_bf16 v[40:43], v[8:11], a[192:199], v3 abid:1
    v_mov_b64_dpp v[14:15], v[4:5] row_newbcast:5 row_mask:0xf bank_mask:0xf
    v_smfmac_f32_16x16x64_bf16 v[16:19], v[8:11], a[200:207], v3 abid:1
    v_mov_b64_dpp v[8:9], v[4:5] row_newbcast:8 row_mask:0xf bank_mask:0xf
    v_smfmac_f32_16x16x64_bf16 v[40:43], v[12:15], a[208:215], v3 abid:1
    v_mov_b64_dpp v[10:11], v[4:5] row_newbcast:9 row_mask:0xf bank_mask:0xf
    v_smfmac_f32_16x16x64_bf16 v[16:19], v[12:15], a[216:223], v3 abid:1
    v_mov_b64_dpp v[12:13], v[4:5] row_newbcast:12 row_mask:0xf bank_mask:0xf
    v_smfmac_f32_16x16x64_bf16 v[40:43], v[8:11], a[224:231], v3 abid:1
    v_mov_b64_dpp v[14:15], v[4:5] row_newbcast:13 row_mask:0xf bank_mask:0xf
    v_smfmac_f32_16x16x64_bf16 v[16:19], v[8:11], a[232:239], v3 abid:1
    s_nop 0
    v_smfmac_f32_16x16x64_bf16 v[40:43], v[12:15], a[240:247], v3 abid:1
    v_smfmac_f32_16x16x64_bf16 v[16:19], v[12:15], a[248:255], v3 abid:1
    s_cmp_eq_u32 s24, 1
    s_cbranch_scc1 L_heh_31
L_heb_32:
L_chain:
    s_mov_b32 exec_lo, 0
    s_mov_b32 exec_hi, 0x80000000
    ds_write_b64 v46, v[44:45] offset:32
    s_mov_b32 exec_lo, 65535
    s_mov_b32 exec_hi, 0
    s_nop 0
    ds_write_b128 v46, v[40:43] offset:0
    ds_write_b128 v46, v[16:19] offset:16
    s_mov_b64 exec, -1
    v_lshrrev_b32 v6, 8, v0
    v_lshrrev_b32 v7, 4, v0
    v_lshl_add_u32 v6, v6, 2, v7
    v_and_b32 v6, 7, v6
    v_lshlrev_b32 v6, 4, v6
    v_add_u32 v6, 4096, v6
    v_lshrrev_b32 v7, 1, v0
    v_mov_b32 v5, 0
    v_and_b32 v46, 0x3c0, v0
    v_lshlrev_b32_e64 v46, 2, v46
    v_bfe_u32 v4, v0, 4, 2
    v_lshl_add_u32 v4, v4, 2, v46
    v_mov_b32 v46, 4096
    s_waitcnt lgkmcnt(0)
    s_barrier
    s_cmp_lg_u32 s3, 0
    s_cbranch_scc1 L_w_33
    ds_read2st64_b64 v[16:19], v5 offset0:4 offset1:5
    ds_read2st64_b64 v[20:23], v5 offset0:6 offset1:7
    ds_read_b64 v[8:9], v7 offset:0
    ds_read_b64 v[10:11], v7 offset:512
    ds_read_b64 v[12:13], v7 offset:1024
    ds_read_b64 v[14:15], v7 offset:1536
    s_waitcnt lgkmcnt(4)
    v_max3_f32 v44, v16, v18, v20
    v_max_f32 v44, v44, v22
    v_sub_f32 v16, v16, v44
    v_sub_f32 v18, v18, v44
    v_sub_f32 v20, v20, v44
    v_sub_f32 v22, v22, v44
    v_exp_f32 v16, v16
    v_exp_f32 v18, v18
    v_exp_f32 v20, v20
    v_exp_f32_e64 v22, v22
    s_waitcnt lgkmcnt(0)
    v_pk_mul_f32 v[8:9], v[8:9], v[16:17] op_sel_hi:[1,0]
    v_mul_f32 v45, v16, v17
    v_pk_fma_f32 v[8:9], v[10:11], v[18:19], v[8:9] op_sel_hi:[1,0,1]
    v_fmac_f32 v45, v18, v19
    v_pk_fma_f32 v[8:9], v[12:13], v[20:21], v[8:9] op_sel_hi:[1,0,1]
    v_fmac_f32 v45, v20, v21
    v_pk_fma_f32 v[8:9], v[14:15], v[22:23], v[8:9] op_sel_hi:[1,0,1]
    v_fmac_f32 v45, v22, v23
    v_cvt_pk_bf16_f32 v10, v8, v9
    v_lshlrev_b32_e64 v12, 16, v10
    v_and_b32 v13, 0xffff0000, v10
    v_pk_add_f32 v[8:9], v[8:9], v[12:13] neg_lo:[0,1] neg_hi:[0,1]
    v_cvt_pk_bf16_f32 v11, v8, v9
    s_cmp_eq_u32 s25, 0
    s_cbranch_scc1 L_slow_34
    buffer_store_dword v10, v4, s[16:19], s89 offen
    buffer_store_dword v11, v4, s[16:19], s89 offen offset:128
    s_mov_b32 exec_lo, 1
    s_mov_b32 exec_hi, 0
    buffer_store_dwordx2 v[44:45], v46, s[16:19], s89 offen
    s_mov_b64 exec, -1
L_slowb_35:
L_w_33:
    s_barrier
    s_add_u32 s89, s89, 0x40000
    s_bitcmp1_b32 s7, 0
    s_cbranch_scc1 L_orole
    s_cmp_eq_u32 s24, 1
    s_cbranch_scc1 L_Ah_39
    s_lshl_b32 s27, s3, 1
    v_bfe_u32 v46, v0, 6, 3
    v_xor_b32 v46, s27, v46
    v_bfe_u32 v7, v0, 4, 2
    v_lshl_add_u32 v46, v46, 2, v7
    v_bfe_u32 v7, v0, 6, 2
    v_lshl_add_u32 v46, v7, 5, v46
    v_lshrrev_b32 v7, 8, v0
    v_lshl_add_u32 v46, v7, 8, v46
    v_lshlrev_b32 v46, 3, v46
    v_add_u32 v46, 53248, v46
    v_xor_b32_e64 v7, 32, v46
    ds_read_b64_tr_b16 v[24:25], v46 offset:0
    ds_read_b64_tr_b16 v[26:27], v46 offset:1024
    ds_read_b64_tr_b16 v[28:29], v46 offset:8192
    ds_read_b64_tr_b16 v[30:31], v46 offset:9216
    ds_read_b64_tr_b16 v[32:33], v46 offset:16384
    ds_read_b64_tr_b16 v[34:35], v46 offset:17408
    ds_read_b64_tr_b16 v[36:37], v46 offset:24576
    ds_read_b64_tr_b16 v[38:39], v46 offset:25600
    ds_read_b64_tr_b16 v[48:49], v7 offset:0
    ds_read_b64_tr_b16 v[50:51], v7 offset:1024
    ds_read_b64_tr_b16 v[52:53], v7 offset:8192
    ds_read_b64_tr_b16 v[54:55], v7 offset:9216
    ds_read_b64_tr_b16 v[56:57], v7 offset:16384
    ds_read_b64_tr_b16 v[58:59], v7 offset:17408
    ds_read_b64_tr_b16 v[60:61], v7 offset:24576
    ds_read_b64_tr_b16 v[62:63], v7 offset:25600
    v_lshrrev_b32_e64 v7, 2, v0
    buffer_load_dwordx2 v[4:5], v6, s[16:19], s88 offen sc1
    buffer_load_dwordx4 v[8:11], v0, s[16:19], s88 offen offset:0 sc1
    buffer_load_dwordx4 v[12:15], v0, s[16:19], s88 offen offset:1024 sc1
    buffer_load_dwordx4 v[16:19], v0, s[16:19], s88 offen offset:2048 sc1
    buffer_load_dwordx4 v[20:23], v0, s[16:19], s88 offen offset:3072 sc1
L_Aw_36:
    s_waitcnt vmcnt(0)
L_Ac_37:
    s_waitcnt lgkmcnt(0)
    v_max3_u32 v44, v4, v5, v8
    v_max3_u32 v44, v44, v9, v10
    v_mfma_f32_16x16x32_bf16 v[40:43], v[8:11], v[24:27], 0
    v_max3_u32 v44, v44, v11, v12
    v_max3_u32 v44, v44, v13, v14
    v_max_f32_dpp v45, v4, v4 row_ror:1 row_mask:0xf bank_mask:0xf
    v_max3_u32 v44, v44, v15, v16
    v_max3_u32 v44, v44, v17, v18
    v_mfma_f32_16x16x32_bf16 v[40:43], v[12:15], v[28:31], v[40:43]
    v_max3_u32 v44, v44, v19, v20
    v_max3_u32 v44, v44, v21, v22
    v_max_f32_dpp v45, v45, v45 row_ror:2 row_mask:0xf bank_mask:0xf
    v_max_u32 v44, v44, v23
    v_cmp_eq_u32 vcc, -1, v44
    v_mfma_f32_16x16x32_bf16 v[40:43], v[16:19], v[32:35], v[40:43]
    v_max_f32_dpp v45, v45, v45 row_ror:4 row_mask:0xf bank_mask:0xf
    v_mfma_f32_16x16x32_bf16 v[40:43], v[20:23], v[36:39], v[40:43]
    v_sub_f32 v46, v4, v45
    v_exp_f32 v46, v46
    s_cbranch_vccnz L_Ar_38
    v_mfma_f32_16x16x32_bf16 v[24:27], v[8:11], v[48:51], 0
    v_mul_f32 v5, v46, v5
    s_add_u32 s88, s88, 0x40000
    v_mfma_f32_16x16x32_bf16 v[24:27], v[12:15], v[52:55], v[24:27]
    v_add_f32_dpp v5, v5, v5 row_ror:1 row_mask:0xf bank_mask:0xf
    v_mul_f32_dpp v44, v46, v40 row_newbcast:0 row_mask:0xf bank_mask:0xf
    v_mfma_f32_16x16x32_bf16 v[24:27], v[16:19], v[56:59], v[24:27]
    v_add_f32_dpp v5, v5, v5 row_ror:2 row_mask:0xf bank_mask:0xf
    v_mul_f32_dpp v45, v46, v41 row_newbcast:1 row_mask:0xf bank_mask:0xf
    v_mfma_f32_16x16x32_bf16 v[24:27], v[20:23], v[60:63], v[24:27]
    v_add_f32_dpp v5, v5, v5 row_ror:4 row_mask:0xf bank_mask:0xf
    v_fmac_f32_dpp v44, v46, v42 row_newbcast:2 row_mask:0xf bank_mask:0xf
    v_fmac_f32_dpp v45, v46, v43 row_newbcast:3 row_mask:0xf bank_mask:0xf
    v_rcp_f32 v5, v5
    v_add_f32 v44, v44, v45
    s_add_u32 s28, s90, 0
    s_add_u32 s90, s90, 0x10000
    s_nop 0
    v_mul_f32_dpp v28, v46, v24 row_newbcast:0 row_mask:0xf bank_mask:0xf
    v_mul_f32_dpp v29, v46, v25 row_newbcast:1 row_mask:0xf bank_mask:0xf
    v_mul_f32_dpp v30, v46, v26 row_newbcast:2 row_mask:0xf bank_mask:0xf
    v_mul_f32_dpp v31, v46, v27 row_newbcast:3 row_mask:0xf bank_mask:0xf
    v_pk_add_f32 v[28:29], v[28:29], v[30:31]
    v_add_f32 v45, v28, v29
    s_nop 1
    v_permlane16_swap_b32 v44, v45
    v_add_f32 v44, v44, v45
    v_mov_b32 v45, v44
    s_nop 1
    v_permlane32_swap_b32 v45, v44
    v_add_f32 v44, v44, v45
    v_mul_f32_e64 v44, v44, v5
    s_mov_b32 exec_lo, -1
    s_mov_b32 exec_hi, 0
    buffer_store_dword v44, v7, s[16:19], s28 offen sc1
    s_mov_b64 exec, -1
    s_bitcmp1_b32 s24, 0
    s_cbranch_scc1 L_odd
    s_lshl_b32 s27, s3, 1
    v_bfe_u32 v45, v0, 6, 3
    v_xor_b32_e64 v45, s27, v45
    v_bfe_u32 v4, v0, 4, 2
    v_lshl_add_u32 v45, v45, 2, v4
    v_bfe_u32 v4, v0, 6, 2
    v_lshl_add_u32 v45, v4, 5, v45
    v_lshrrev_b32 v4, 8, v0
    v_lshl_add_u32 v45, v4, 8, v45
    v_lshlrev_b32 v45, 3, v45
    v_add_u32 v45, 20480, v45
    v_xor_b32_e64 v4, 32, v45
    ds_read_b64_tr_b16 v[24:25], v45 offset:0
    ds_read_b64_tr_b16 v[26:27], v45 offset:1024
    ds_read_b64_tr_b16 v[28:29], v45 offset:8192
    ds_read_b64_tr_b16 v[30:31], v45 offset:9216
    ds_read_b64_tr_b16 v[32:33], v45 offset:16384
    ds_read_b64_tr_b16 v[34:35], v45 offset:17408
    ds_read_b64_tr_b16 v[36:37], v45 offset:24576
    ds_read_b64_tr_b16 v[38:39], v45 offset:25600
    ds_read_b64_tr_b16 v[48:49], v4 offset:0
    ds_read_b64_tr_b16 v[50:51], v4 offset:1024
    ds_read_b64_tr_b16 v[52:53], v4 offset:8192
    ds_read_b64_tr_b16 v[54:55], v4 offset:9216
    ds_read_b64_tr_b16 v[56:57], v4 offset:16384
    ds_read_b64_tr_b16 v[58:59], v4 offset:17408
    ds_read_b64_tr_b16 v[60:61], v4 offset:24576
    ds_read_b64_tr_b16 v[62:63], v4 offset:25600
L_hopB:
    s_lshl_b32 s27, s32, 2
    v_bfe_u32 v46, v0, 4, 4
    v_add_u32 v46, s27, v46
    v_and_b32 v46, 15, v46
    v_lshlrev_b32 v46, 7, v46
    v_lshrrev_b32 v6, 8, v0
    v_lshl_add_u32 v46, v6, 5, v46
    v_lshrrev_b32 v5, 3, v46
    v_and_b32 v5, 0xf0, v5
    v_lshl_add_u32 v5, v6, 8, v5
    s_cmp_lg_u32 s3, 0
    s_cbranch_scc1 L_Bo_41
    v_and_b32 v6, 0x70, v0
    v_lshrrev_b32_e64 v7, 8, v0
    v_lshl_add_u32 v6, v7, 2, v6
    v_add_u32 v6, s61, v6
    ds_read_b32 v45, v6 offset:2112
    v_lshlrev_b32 v6, 2, v7
    v_bfe_u32 v7, v0, 4, 1
    v_lshl_add_u32 v6, v7, 10, v6
    v_bfe_u32 v7, v0, 5, 2
    v_lshl_add_u32 v6, v7, 8, v6
    s_waitcnt vmcnt(0)
    buffer_load_dwordx4 v[8:11], v0, s[16:19], s91 offen offset:0 sc1
    buffer_load_dwordx4 v[12:15], v0, s[16:19], s91 offen offset:1024 sc1
    buffer_load_dwordx4 v[16:19], v0, s[16:19], s91 offen offset:2048 sc1
    buffer_load_dwordx4 v[20:23], v0, s[16:19], s91 offen offset:3072 sc1
L_Bw_42:
    s_waitcnt vmcnt(0)
L_Bc_43:
    v_pk_add_f32 v[40:41], v[8:9], v[12:13]
    v_max3_u32 v44, v8, v9, v10
    v_max3_u32 v44, v44, v11, v12
    v_pk_add_f32 v[42:43], v[10:11], v[14:15]
    v_max3_u32 v44, v44, v13, v14
    v_max3_u32 v44, v44, v15, v16
    v_pk_add_f32 v[40:41], v[40:41], v[16:17]
    v_max3_u32 v44, v44, v17, v18
    v_max3_u32 v44, v44, v19, v20
    v_pk_add_f32 v[42:43], v[42:43], v[18:19]
    v_max3_u32 v44, v44, v21, v22
    v_max_u32_e64 v44, v44, v23
    v_pk_add_f32 v[40:41], v[40:41], v[20:21]
    v_cmp_eq_u32 vcc, -1, v44
    v_pk_add_f32 v[42:43], v[42:43], v[22:23]
    s_waitcnt lgkmcnt(0)
    s_cbranch_vccnz L_Br_44
    v_permlane32_swap_b32 v40, v42
    v_permlane32_swap_b32 v41, v43
    v_pk_add_f32 v[40:41], v[40:41], v[42:43]
    s_cmp_eq_u32 s25, 0
    s_nop 0
    v_permlane16_swap_b32 v40, v41
    v_add_f32_e64 v8, v40, v41
    s_nop 0
    s_nop 0
    v_add_f32_dpp v8, v8, v8 row_ror:8 row_mask:0xf bank_mask:0xf
    v_add_f32_e64 v8, v8, v45
    s_mov_b32 exec_lo, 16711935
    s_mov_b32 exec_hi, 16711935
    s_cbranch_scc1 L_slow_46
    buffer_store_dword v8, v6, s[16:19], s92 offen
L_slowb_47:
    s_mov_b64 exec, -1
    s_cmp_eq_u32 s24, 3
    s_cbranch_scc1 L_fin1
L_B2_40:
    s_barrier
    buffer_load_dwordx4 v[8:11], v5, s[16:19], s93 offen sc1
    buffer_load_dwordx4 v[12:15], v5, s[16:19], s93 offen offset:1024 sc1
L_Xw_48:
    s_waitcnt vmcnt(0)
L_Xc_49:
    v_pk_add_f32 v[16:17], v[8:9], v[10:11]
    v_max3_u32 v44, v8, v9, v10
    v_max3_u32 v44, v44, v11, v12
    v_pk_mul_f32 v[20:21], v[8:9], v[8:9]
    v_max3_u32 v44, v44, v13, v14
    v_max_u32 v44, v44, v15
    v_pk_add_f32 v[18:19], v[12:13], v[14:15]
    v_cmp_eq_u32 vcc, -1, v44
    v_pk_fma_f32 v[20:21], v[10:11], v[10:11], v[20:21]
    v_pk_add_f32 v[16:17], v[16:17], v[18:19]
    v_pk_fma_f32 v[20:21], v[12:13], v[12:13], v[20:21]
    v_add_f32 v16, v16, v17
    v_pk_fma_f32 v[20:21], v[14:15], v[14:15], v[20:21]
    v_add_f32_e64 v20, v20, v21
    s_cbranch_vccnz L_Xr_50
    v_mov_b32 v19, 0x2edbe6ff
    v_mov_b32 v18, 0x3f800054
    v_permlane32_swap_b32 v16, v20
    v_add_f32 v16, v16, v20
    v_mov_b32_e64 v20, v16
    s_add_u32 s91, s91, 0x20000
    s_add_u32 s93, s93, 0x8000
    v_permlane16_swap_b32 v20, v16
    v_add_f32 v16, v16, v20
    s_add_u32 s92, s92, 0x8000
    s_nop 0
    v_add_f32_dpp v16, v16, v16 row_ror:1 row_mask:0xf bank_mask:0xf
    s_nop 1
    v_add_f32_dpp v16, v16, v16 row_ror:2 row_mask:0xf bank_mask:0xf
    s_nop 0
    s_nop 0
    v_add_f32_dpp v16, v16, v16 row_ror:4 row_mask:0xf bank_mask:0xf
    s_nop 1
    v_add_f32_dpp v16, v16, v16 row_ror:8 row_mask:0xf bank_mask:0xf
    v_mul_f32 v16, 0x3b000000, v16
    v_mov_b32 v20, v16
    s_nop 1
    v_permlane32_swap_b32 v16, v20
    v_fma_f32 v20, -v16, v16, v20
    v_fma_f32 v20, abs(v20), v18, v19
    v_rsq_f32_e64 v40, v20
    v_pk_add_f32 v[22:23], v[14:15], v[16:17] op_sel_hi:[1,0] neg_lo:[0,1] neg_hi:[0,1]
    v_pk_add_f32 v[20:21], v[12:13], v[16:17] op_sel_hi:[1,0] neg_lo:[0,1] neg_hi:[0,1]
    v_pk_add_f32 v[18:19], v[10:11], v[16:17] op_sel_hi:[1,0] neg_lo:[0,1] neg_hi:[0,1]
    v_pk_add_f32 v[16:17], v[8:9], v[16:17] op_sel_hi:[1,0] neg_lo:[0,1] neg_hi:[0,1]
    v_pk_mul_f32 v[22:23], v[22:23], v[40:41] op_sel_hi:[1,0]
    v_pk_mul_f32 v[20:21], v[20:21], v[40:41] op_sel_hi:[1,0]
    v_pk_mul_f32 v[18:19], v[18:19], v[40:41] op_sel_hi:[1,0]
    v_pk_mul_f32 v[16:17], v[16:17], v[40:41] op_sel_hi:[1,0]
    v_cvt_pk_bf16_f32 v4, v16, v17
    v_cvt_pk_bf16_f32 v5, v18, v19
    v_cvt_pk_bf16_f32 v6, v20, v21
    v_cvt_pk_bf16_f32 v7, v22, v23
    v_and_b32 v40, 0x7fff7fff, v4
    v_and_b32 v41, 0x7fff7fff, v5
    v_and_b32 v42, 0x7fff7fff, v6
    v_and_b32 v43, 0x7fff7fff, v7
    v_pk_sub_u16 v20, v40, s62 clamp
    v_pk_sub_u16 v21, v41, s62 clamp
    v_pk_sub_u16 v22, v42, s62 clamp
    v_pk_sub_u16 v23, v43, s62 clamp
    v_lshrrev_b32 v16, 3, v4
    v_lshrrev_b32 v17, 3, v5
    v_lshrrev_b32 v18, 3, v6
    v_lshrrev_b32 v19, 3, v7
    v_and_or_b32 v20, v16, s63, v20
    v_and_or_b32 v21, v17, s63, v21
    v_and_or_b32 v22, v18, s63, v22
    v_and_or_b32 v23, v19, s63, v23
    v_lshlrev_b32_sdwa v16, 1, v20 dst_sel:DWORD dst_unused:UNUSED_PAD src0_sel:DWORD src1_sel:WORD_0
    v_lshlrev_b32_sdwa v17, 1, v20 dst_sel:DWORD dst_unused:UNUSED_PAD src0_sel:DWORD src1_sel:WORD_1
    ds_read_u16 v16, v16 offset:4096
    ds_read_u16 v17, v17 offset:4096
    v_lshlrev_b32_sdwa v18, 1, v21 dst_sel:DWORD dst_unused:UNUSED_PAD src0_sel:DWORD src1_sel:WORD_0
    v_lshlrev_b32_sdwa v19, 1, v21 dst_sel:DWORD dst_unused:UNUSED_PAD src0_sel:DWORD src1_sel:WORD_1
    ds_read_u16 v18, v18 offset:4096
    ds_read_u16 v19, v19 offset:4096
    v_lshlrev_b32_sdwa v20, 1, v22 dst_sel:DWORD dst_unused:UNUSED_PAD src0_sel:DWORD src1_sel:WORD_0
    v_lshlrev_b32_sdwa v21, 1, v22 dst_sel:DWORD dst_unused:UNUSED_PAD src0_sel:DWORD src1_sel:WORD_1
    ds_read_u16 v20, v20 offset:4096
    ds_read_u16 v21, v21 offset:4096
    v_lshlrev_b32_sdwa v22, 1, v23 dst_sel:DWORD dst_unused:UNUSED_PAD src0_sel:DWORD src1_sel:WORD_0
    v_lshlrev_b32_sdwa v23, 1, v23 dst_sel:DWORD dst_unused:UNUSED_PAD src0_sel:DWORD src1_sel:WORD_1
    ds_read_u16 v22, v22 offset:4096
    ds_read_u16 v23, v23 offset:4096
    v_pk_max_u16 v44, v40, v41
    v_pk_max_u16 v45, v42, v43
    v_pk_sub_u16 v40, v40, s43
    v_pk_sub_u16 v41, v41, s43
    v_pk_sub_u16 v42, v42, s43
    v_pk_sub_u16 v43, v43, s43
    v_pk_max_u16 v45, v44, v45
    v_pk_min_u16 v40, v40, v41
    v_pk_min_u16 v42, v42, v43
    v_pk_sub_u16 v45, v45, s42 clamp
    v_pk_min_u16 v40, v40, v42
    v_pk_sub_u16 v44, s62, v40 clamp
    v_or_b32 v44, v44, v45
    v_cmp_ne_u32 vcc, 0, v44
    s_cbranch_vccnz L_tiny
L_tinyb:
    s_cmp_eq_u32 s24, 3
    s_waitcnt lgkmcnt(6)
    v_lshlrev_b32 v16, 16, v16
    v_lshlrev_b32 v17, 16, v17
    v_pk_add_f32 v[8:9], v[8:9], v[16:17]
    s_waitcnt lgkmcnt(4)
    v_lshlrev_b32 v18, 16, v18
    v_lshlrev_b32 v19, 16, v19
    v_pk_add_f32 v[10:11], v[10:11], v[18:19]
    s_waitcnt lgkmcnt(2)
    v_lshlrev_b32 v20, 16, v20
    v_lshlrev_b32 v21, 16, v21
    v_pk_add_f32 v[12:13], v[12:13], v[20:21]
    s_waitcnt lgkmcnt(0)
    v_lshlrev_b32 v22, 16, v22
    v_lshlrev_b32_e64 v23, 16, v23
    v_pk_add_f32 v[14:15], v[14:15], v[22:23]
    s_cbranch_scc1 L_out
    v_pk_add_f32 v[16:17], v[8:9], v[10:11]
    v_pk_mul_f32 v[20:21], v[8:9], v[8:9]
    v_pk_add_f32 v[18:19], v[12:13], v[14:15]
    v_pk_fma_f32 v[20:21], v[10:11], v[10:11], v[20:21]
    v_pk_add_f32 v[16:17], v[16:17], v[18:19]
    v_pk_fma_f32 v[20:21], v[12:13], v[12:13], v[20:21]
    v_add_f32 v16, v16, v17
    v_pk_fma_f32 v[20:21], v[14:15], v[14:15], v[20:21]
    v_add_f32 v20, v20, v21
    v_bfe_u32 v44, v0, 5, 1
    v_bfe_u32 v45, v0, 7, 1
    v_permlane32_swap_b32 v16, v20
    v_add_f32 v16, v16, v20
    v_mov_b32 v20, v16
    v_lshlrev_b32 v44, 4, v44
    v_lshl_add_u32 v44, v45, 10, v44
    v_permlane16_swap_b32 v20, v16
    v_add_f32 v16, v16, v20
    v_bfe_u32 v45, v0, 6, 1
    v_lshl_add_u32 v44, v45, 3, v44
    v_add_f32_dpp v16, v16, v16 row_ror:1 row_mask:0xf bank_mask:0xf
    v_bfe_u32 v45, v0, 4, 1
    v_lshl_add_u32 v44, v45, 2, v44
    v_add_f32_dpp v16, v16, v16 row_ror:2 row_mask:0xf bank_mask:0xf
    v_and_b32 v45, 0x100, v0
    v_add_u32 v44, v44, v45
    v_add_f32_dpp v16, v16, v16 row_ror:4 row_mask:0xf bank_mask:0xf
    v_mov_b32 v19, 0x3727c5ac
    s_nop 0
    v_add_f32_dpp v16, v16, v16 row_ror:8 row_mask:0xf bank_mask:0xf
    v_mul_f32 v16, 0x3b000000, v16
    v_mov_b32 v20, v16
    s_nop 0
    s_nop 0
    v_permlane32_swap_b32 v16, v20
    v_fma_f32 v20, -v16, v16, v20
    v_add_f32 v20, abs(v20), v19
    v_rsq_f32_e64 v40, v20
    s_waitcnt lgkmcnt(0)
    v_pk_add_f32 v[22:23], v[14:15], v[16:17] op_sel_hi:[1,0] neg_lo:[0,1] neg_hi:[0,1]
    v_pk_add_f32 v[20:21], v[12:13], v[16:17] op_sel_hi:[1,0] neg_lo:[0,1] neg_hi:[0,1]
    v_pk_add_f32 v[18:19], v[10:11], v[16:17] op_sel_hi:[1,0] neg_lo:[0,1] neg_hi:[0,1]
    v_pk_add_f32 v[16:17], v[8:9], v[16:17] op_sel_hi:[1,0] neg_lo:[0,1] neg_hi:[0,1]
    v_pk_mul_f32 v[22:23], v[22:23], v[40:41] op_sel_hi:[1,0]
    v_pk_mul_f32 v[20:21], v[20:21], v[40:41] op_sel_hi:[1,0]
    v_pk_mul_f32 v[18:19], v[18:19], v[40:41] op_sel_hi:[1,0]
    v_pk_mul_f32 v[16:17], v[16:17], v[40:41] op_sel_hi:[1,0]
    v_cvt_pk_bf16_f32 v4, v16, v17
    v_cvt_pk_bf16_f32 v5, v18, v19
    v_cvt_pk_bf16_f32 v6, v20, v21
    v_cvt_pk_bf16_f32 v7, v22, v23
    v_mov_b64_dpp v[16:17], v[4:5] row_newbcast:1 row_mask:0xf bank_mask:0xf
    s_nop 0
    v_mfma_f32_16x16x32_bf16 v[40:43], v[4:7], v[24:27], 0
    v_mov_b64_dpp v[18:19], v[6:7] row_newbcast:1 row_mask:0xf bank_mask:0xf
    v_mfma_f32_16x16x32_bf16 v[24:27], v[4:7], v[48:51], 0
    v_mov_b64_dpp v[20:21], v[4:5] row_newbcast:2 row_mask:0xf bank_mask:0xf
    v_mov_b64_dpp v[22:23], v[6:7] row_newbcast:2 row_mask:0xf bank_mask:0xf
    v_mfma_f32_16x16x32_bf16 v[40:43], v[16:19], v[28:31], v[40:43]
    v_mfma_f32_16x16x32_bf16 v[24:27], v[16:19], v[52:55], v[24:27]
    v_mov_b64_dpp v[16:17], v[4:5] row_newbcast:3 row_mask:0xf bank_mask:0xf
    v_mov_b64_dpp v[18:19], v[6:7] row_newbcast:3 row_mask:0xf bank_mask:0xf
    v_mfma_f32_16x16x32_bf16 v[40:43], v[20:23], v[32:35], v[40:43]
    v_mfma_f32_16x16x32_bf16 v[24:27], v[20:23], v[56:59], v[24:27]
    v_mfma_f32_16x16x32_bf16 v[40:43], v[16:19], v[36:39], v[40:43]
    v_mfma_f32_16x16x32_bf16 v[24:27], v[16:19], v[60:63], v[24:27]
    s_cmp_eq_u32 s25, 0
    s_nop 6
    v_permlane16_swap_b32 v40, v24
    s_mov_b32 exec_lo, -1
    s_mov_b32 exec_hi, 0
    s_cbranch_scc1 L_slow_52
    buffer_store_dword v40, v44, s[16:19], s94 offen
L_slowb_53:
    s_mov_b64 exec, -1
    s_cmp_lg_u32 s3, 0
    s_cbranch_scc1 L_w_54
    v_lshrrev_b32 v44, 7, v46
    v_and_b32 v45, 0x60, v46
    v_cmp_eq_u32 vcc, s31, v44
    v_add_u32 v45, s61, v45
    s_mov_b64 exec, vcc
    ds_write_b128 v45, v[8:11] offset:2112
    ds_write_b128 v45, v[12:15] offset:2128
    s_mov_b64 exec, -1
L_w_54:
    s_add_u32 s94, s94, 0x20000
    v_mov_b64 v[24:25], 0
    v_mov_b64 v[26:27], 0
    v_mov_b64 v[28:29], 0
    v_mov_b64 v[30:31], 0
    v_mov_b64 v[32:33], 0
    v_mov_b64 v[34:35], 0
    v_mov_b64 v[40:41], 0
    v_mov_b64_e64 v[42:43], 0
    v_add_u32_e64 v36, s30, v0
    s_lshl_b32 s27, s3, 9
    v_lshl_add_u32 v46, v0, 1, s27
    s_waitcnt vmcnt(0)
L_hopQ:
    buffer_load_dwordx4 v[8:11], v0, s[16:19], s95 offen offset:0 sc1
    buffer_load_dwordx4 v[12:15], v0, s[16:19], s95 offen offset:1024 sc1
L_Qw_55:
    s_waitcnt vmcnt(0)
L_Qc_56:
    v_max3_u32 v44, v8, v9, v10
    v_max3_u32 v44, v44, v11, v12
    v_max3_u32 v44, v44, v13, v14
    v_max_u32 v44, v44, v15
    v_cmp_eq_u32 vcc, -1, v44
    s_cbranch_vccnz L_Qr_57
L_qok:
    s_cmp_eq_u32 s24, 0
    s_cbranch_scc1 L_seh_59
L_seb_60:
    s_add_u32 s95, s95, 0x10000
    s_add_u32 s24, s24, 1
    v_add_f32_dpp v8, v8, v8 row_ror:4 row_mask:0xf bank_mask:0xf
    v_add_f32_dpp v9, v9, v9 row_ror:4 row_mask:0xf bank_mask:0xf
    v_add_f32_dpp v10, v10, v10 row_ror:4 row_mask:0xf bank_mask:0xf
    v_add_f32_dpp v11, v11, v11 row_ror:4 row_mask:0xf bank_mask:0xf
    v_add_f32_dpp v12, v12, v12 row_ror:4 row_mask:0xf bank_mask:0xf
    v_add_f32_dpp v13, v13, v13 row_ror:4 row_mask:0xf bank_mask:0xf
    v_add_f32_dpp v14, v14, v14 row_ror:4 row_mask:0xf bank_mask:0xf
    v_add_f32_dpp v15, v15, v15 row_ror:4 row_mask:0xf bank_mask:0xf
    v_add_f32_dpp v8, v8, v8 row_ror:8 row_mask:0xf bank_mask:0xf
    v_add_f32_dpp v9, v9, v9 row_ror:8 row_mask:0xf bank_mask:0xf
    v_add_f32_dpp v10, v10, v10 row_ror:8 row_mask:0xf bank_mask:0xf
    v_add_f32_dpp v11, v11, v11 row_ror:8 row_mask:0xf bank_mask:0xf
    v_add_f32_dpp v12, v12, v12 row_ror:8 row_mask:0xf bank_mask:0xf
    v_add_f32_dpp v13, v13, v13 row_ror:8 row_mask:0xf bank_mask:0xf
    v_add_f32_dpp v14, v14, v14 row_ror:8 row_mask:0xf bank_mask:0xf
    v_add_f32_dpp v15, v15, v15 row_ror:8 row_mask:0xf bank_mask:0xf
    v_cvt_pk_bf16_f32 v4, v8, v9
    v_cvt_pk_bf16_f32 v5, v10, v11
    v_cvt_pk_bf16_f32 v6, v12, v13
    v_cvt_pk_bf16_f32 v7, v14, v15
    v_cndmask_b32 v8, 0, v4, s[80:81]
    v_cndmask_b32 v9, 0, v5, s[80:81]
    v_cndmask_b32 v10, 0, v6, s[80:81]
    v_cndmask_b32 v11, 0, v7, s[80:81]
    s_branch L_pass2
L_orole:
    s_cmp_eq_u32 s24, 3
    s_cbranch_scc1 L_exit
    s_cmp_eq_u32 s24, 1
    s_cbranch_scc1 L_o1
    v_mov_b64 v[24:25], 0
    v_mov_b64 v[26:27], 0
    v_mov_b64 v[28:29], 0
    v_mov_b64_e64 v[30:31], 0
    v_mov_b64_e64 v[32:33], 0
    v_mov_b64 v[34:35], 0
    v_mov_b64_e64 v[40:41], 0
    v_mov_b64_e64 v[42:43], 0
    v_add_u32_e64 v36, s30, v0
    s_lshl_b32 s27, s3, 9
    v_lshl_add_u32 v46, v0, 1, s27
    s_cmp_eq_u32 s24, 2
    s_cbranch_scc1 L_o2
    s_sub_u32 s33, s75, 0x40000
    v_lshlrev_b32_e64 v45, 3, v0
    s_mov_b32 m0, 2624
    s_mov_b32 exec_hi, 0
    buffer_load_dword v45, s[8:11], s33 offen lds
    s_mov_b32 exec_hi, -1
    s_add_u32 s33, s33, 16384
    s_call_b64 s[58:59], L_nxt
    s_call_b64 s[58:59], L_nxt
    s_call_b64 s[58:59], L_nxt
    s_mov_b32 m0, 2624
    s_mov_b32 exec_hi, 0
    buffer_load_dword v45, s[8:11], s33 offen lds
    s_mov_b32 exec_hi, -1
    s_add_u32 s33, s33, 16384
    s_call_b64 s[58:59], L_nxt
    s_call_b64 s[58:59], L_nxt
    s_call_b64 s[58:59], L_nxt
    s_mov_b32 m0, 2624
    s_mov_b32 exec_hi, 0
    buffer_load_dword v45, s[8:11], s33 offen lds
    s_mov_b32 exec_hi, -1
    s_add_u32 s33, s33, 16384
    s_call_b64 s[58:59], L_nxt
    s_call_b64 s[58:59], L_nxt
    s_mov_b32 m0, 2624
    s_mov_b32 exec_hi, 0
    buffer_load_dword v45, s[8:11], s33 offen lds
    s_mov_b32 exec_hi, -1
    s_add_u32 s33, s33, 16384
    s_mov_b32 m0, 2624
    s_mov_b32 exec_hi, 0
    buffer_load_dword v45, s[8:11], s33 offen lds
    s_mov_b32 exec_hi, -1
    s_add_u32 s33, s33, 16384
    s_branch L_hopQ
L_o2:
    v_lshlrev_b32_e64 v45, 3, v0
    s_mov_b32 m0, 2624
    s_mov_b32 exec_hi, 0
    s_sub_u32 s33, s79, 0x4040000
    buffer_load_dword v45, s[12:15], s33 offen lds
    s_sub_u32 s33, s78, 0x4040000
    buffer_load_dword v45, s[12:15], s33 offen lds
    s_mov_b32 exec_hi, -1
    s_branch L_hopQ
L_o1:
    v_add_u32 v46, s37, v0
    ds_read_b128 a[0:3], v46 offset:0
    ds_read_b128 a[4:7], v46 offset:1024
    ds_read_b128 a[8:11], v46 offset:2048
    ds_read_b128 a[12:15], v46 offset:3072
    s_waitcnt vmcnt(7)
    buffer_load_dwordx4 a[96:99], v1, s[8:11], s70 offen offset:0 nt
    ds_read_b128 a[16:19], v46 offset:4096
    ds_read_b128 a[20:23], v46 offset:5120
    ds_read_b128 a[24:27], v46 offset:6144
    ds_read_b128 a[28:31], v46 offset:7168
    s_waitcnt vmcnt(7)
    buffer_load_dwordx4 a[100:103], v1, s[8:11], s70 offen offset:128 nt
    s_waitcnt vmcnt(7)
    buffer_load_dwordx4 a[104:107], v1, s[8:11], s70 offen offset:2048 nt
    s_waitcnt vmcnt(7)
    buffer_load_dwordx4 a[108:111], v1, s[8:11], s70 offen offset:2176 nt
    s_waitcnt vmcnt(7)
    buffer_load_dwordx4 a[112:115], v1, s[8:11], s71 offen offset:0 nt
    s_waitcnt vmcnt(7)
    buffer_load_dwordx4 a[116:119], v1, s[8:11], s71 offen offset:128 nt
    s_waitcnt vmcnt(7)
    buffer_load_dwordx4 a[120:123], v1, s[8:11], s71 offen offset:2048 nt
    s_waitcnt vmcnt(7)
    buffer_load_dwordx4 a[124:127], v1, s[8:11], s71 offen offset:2176 nt
    s_waitcnt vmcnt(7)
    buffer_load_dwordx4 a[128:131], v1, s[8:11], s72 offen offset:0 nt
    s_waitcnt vmcnt(7)
    buffer_load_dwordx4 a[132:135], v1, s[8:11], s72 offen offset:128 nt
    s_waitcnt vmcnt(7)
    buffer_load_dwordx4 a[136:139], v1, s[8:11], s72 offen offset:2048 nt
    s_waitcnt vmcnt(7)
    buffer_load_dwordx4 a[140:143], v1, s[8:11], s72 offen offset:2176 nt
    s_waitcnt vmcnt(7)
    buffer_load_dwordx4 a[144:147], v1, s[8:11], s73 offen offset:0 nt
    s_waitcnt vmcnt(7)
    buffer_load_dwordx4 a[148:151], v1, s[8:11], s73 offen offset:128 nt
    s_waitcnt vmcnt(7)
    buffer_load_dwordx4 a[152:155], v1, s[8:11], s73 offen offset:2048 nt
    s_waitcnt vmcnt(7)
    buffer_load_dwordx4 a[156:159], v1, s[8:11], s73 offen offset:2176 nt
    s_waitcnt vmcnt(7)
    buffer_load_dwordx4 a[160:163], v1, s[8:11], s74 offen offset:0 nt
    s_waitcnt vmcnt(7)
    buffer_load_dwordx4 a[164:167], v1, s[8:11], s74 offen offset:128 nt
    s_waitcnt vmcnt(7)
    buffer_load_dwordx4 a[168:171], v1, s[8:11], s74 offen offset:2048 nt
    s_waitcnt vmcnt(7)
    buffer_load_dwordx4 a[172:175], v1, s[8:11], s74 offen offset:2176 nt
    s_waitcnt vmcnt(7)
    buffer_load_dwordx4 a[176:179], v1, s[8:11], s75 offen offset:0 nt
    s_waitcnt vmcnt(7)
    buffer_load_dwordx4 a[180:183], v1, s[8:11], s75 offen offset:128 nt
    s_waitcnt vmcnt(7)
    buffer_load_dwordx4 a[184:187], v1, s[8:11], s75 offen offset:2048 nt
    s_waitcnt vmcnt(7)
    buffer_load_dwordx4 a[188:191], v1, s[8:11], s75 offen offset:2176 nt
    s_waitcnt vmcnt(7)
    buffer_load_dwordx4 a[192:195], v1, s[8:11], s76 offen offset:0 nt
    s_waitcnt vmcnt(7)
    buffer_load_dwordx4 a[196:199], v1, s[8:11], s76 offen offset:128 nt
    s_waitcnt vmcnt(7)
    buffer_load_dwordx4 a[200:203], v1, s[8:11], s76 offen offset:2048 nt
    s_waitcnt vmcnt(7)
    buffer_load_dwordx4 a[204:207], v1, s[8:11], s76 offen offset:2176 nt
    s_waitcnt vmcnt(7)
    buffer_load_dwordx4 a[208:211], v1, s[8:11], s77 offen offset:0 nt
    s_waitcnt vmcnt(7)
    buffer_load_dwordx4 a[212:215], v1, s[8:11], s77 offen offset:128 nt
    s_waitcnt vmcnt(7)
    buffer_load_dwordx4 a[216:219], v1, s[8:11], s77 offen offset:2048 nt
    s_waitcnt vmcnt(7)
    buffer_load_dwordx4 a[220:223], v1, s[8:11], s77 offen offset:2176 nt
    s_waitcnt vmcnt(7)
    buffer_load_dwordx4 a[224:227], v1, s[8:11], s78 offen offset:0 nt
    s_waitcnt vmcnt(7)
    buffer_load_dwordx4 a[228:231], v1, s[8:11], s78 offen offset:128 nt
    s_waitcnt vmcnt(7)
    buffer_load_dwordx4 a[232:235], v1, s[8:11], s78 offen offset:2048 nt
    s_waitcnt vmcnt(7)
    buffer_load_dwordx4 a[236:239], v1, s[8:11], s78 offen offset:2176 nt
    s_waitcnt vmcnt(7)
    buffer_load_dwordx4 a[240:243], v1, s[8:11], s79 offen offset:0 nt
    s_waitcnt vmcnt(7)
    buffer_load_dwordx4 a[244:247], v1, s[8:11], s79 offen offset:128 nt
    s_waitcnt vmcnt(7)
    buffer_load_dwordx4 a[248:251], v1, s[8:11], s79 offen offset:2048 nt
    s_waitcnt vmcnt(7)
    buffer_load_dwordx4 a[252:255], v1, s[8:11], s79 offen offset:2176 nt
    s_waitcnt lgkmcnt(0)
    s_branch L_next
L_odd:
    s_cmp_eq_u32 s24, 3
    s_cbranch_scc1 L_last
    v_add_u32 v46, s37, v0
    ds_read_b128 a[0:3], v46 offset:0
    ds_read_b128 a[4:7], v46 offset:1024
    ds_read_b128 a[8:11], v46 offset:2048
    s_waitcnt vmcnt(11)
    buffer_load_dwordx4 a[252:255], v1, s[8:11], s79 offen offset:2176 nt
    s_waitcnt vmcnt(11)
    buffer_load_dwordx4 a[124:127], v1, s[8:11], s71 offen offset:2176 nt
    s_waitcnt vmcnt(11)
    buffer_load_dwordx4 a[128:131], v1, s[8:11], s72 offen offset:0 nt
    s_waitcnt vmcnt(11)
    buffer_load_dwordx4 a[132:135], v1, s[8:11], s72 offen offset:128 nt
    s_waitcnt vmcnt(11)
    buffer_load_dwordx4 a[136:139], v1, s[8:11], s72 offen offset:2048 nt
    s_waitcnt vmcnt(11)
    buffer_load_dwordx4 a[140:143], v1, s[8:11], s72 offen offset:2176 nt
    s_waitcnt vmcnt(11)
    buffer_load_dwordx4 a[144:147], v1, s[8:11], s73 offen offset:0 nt
    s_waitcnt vmcnt(11)
    buffer_load_dwordx4 a[148:151], v1, s[8:11], s73 offen offset:128 nt
    s_waitcnt vmcnt(11)
    buffer_load_dwordx4 a[152:155], v1, s[8:11], s73 offen offset:2048 nt
    s_waitcnt vmcnt(11)
    buffer_load_dwordx4 a[156:159], v1, s[8:11], s73 offen offset:2176 nt
    s_waitcnt vmcnt(11)
    buffer_load_dwordx4 a[160:163], v1, s[8:11], s74 offen offset:0 nt
    s_waitcnt vmcnt(11)
    buffer_load_dwordx4 a[164:167], v1, s[8:11], s74 offen offset:128 nt
    s_waitcnt vmcnt(11)
    buffer_load_dwordx4 a[168:171], v1, s[8:11], s74 offen offset:2048 nt
    s_waitcnt vmcnt(11)
    buffer_load_dwordx4 a[172:175], v1, s[8:11], s74 offen offset:2176 nt
    s_waitcnt lgkmcnt(0)
L_next:
    s_mov_b32 s24, 2
    s_mov_b32 s61, 128
    s_branch L_pass1
L_last:
    s_cmp_lg_u32 s3, 0
    s_cbranch_scc1 L_exit
    s_cmp_ge_u32 s4, 2
    s_cbranch_scc1 L_exit
    s_lshl_b32 s27, s4, 1
    s_add_u32 s27, s27, 1
    s_lshl_b32 s28, s27, 16
    s_sub_u32 s91, s91, s28
    s_lshl_b32 s28, s27, 14
    s_sub_u32 s93, s93, s28
    s_sub_u32 s92, s92, s28
    s_lshl_b32 s28, s4, 7
    s_sub_u32 s61, 128, s28
    s_branch L_hopB
L_out:
    v_cvt_pk_bf16_f32 v4, v8, v9
    v_cvt_pk_bf16_f32 v5, v10, v11
    v_cvt_pk_bf16_f32 v6, v12, v13
    v_cvt_pk_bf16_f32 v7, v14, v15
    s_mov_b32 s20, s52
    s_mov_b32 s21, s53
    s_mov_b32 s22, 2048
    v_lshrrev_b32 v46, 1, v46
    s_lshl_b32 s27, s61, 3
    buffer_store_dwordx4 v[4:7], v46, s[20:23], s27 offen
L_exit:
    s_waitcnt vmcnt(0)
L_end:
    s_endpgm
L_fail:
    s_branch L_exit
L_nxt:
    s_lshr_b32 s100, s34, 2
    s_lshl_b32 s100, s100, 14
    s_add_u32 s100, s100, s64
    s_bfe_u32 s101, s34, 0x10001
    s_lshl_b32 s101, s101, 11
    s_add_u32 s100, s100, s101
    s_and_b32 s101, s34, 1
    s_lshl_b32 s101, s101, 7
    s_add_u32 s100, s100, s101
    s_lshl_b32 s101, s34, 10
    s_add_u32 m0, s101, s37
    s_add_u32 s34, s34, 1
    s_waitcnt vmcnt(5)
    buffer_load_dwordx4 v1, s[8:11], s100 offen nt lds
    s_setpc_b64 s[58:59]
L_gbr_4:
    s_sub_u32 s26, s26, 1
    s_cbranch_scc1 L_fail
    buffer_load_dwordx2 v[6:7], v5, s[16:19], s29 offen sc1
    s_waitcnt vmcnt(0)
    s_branch L_gbc_5
L_slow_9:
    s_nop 1
    buffer_store_dword v40, v44, s[16:19], s94 offen sc1
    s_branch L_slowb_10
L_slow_12:
    buffer_store_dword v40, v44, s[16:19], s94 offen sc1
    s_branch L_slowb_13
L_pro_odd:
    v_mul_u32_u24 v5, 12, v4
    s_mov_b32 s22, 2752
    s_mov_b32 s20, s44
    s_mov_b32 s21, s45
    buffer_load_dwordx4 v[140:143], v0, s[20:23], 0 offen
    buffer_load_dwordx4 v[144:147], v0, s[20:23], 0 offen offset:1024
    buffer_load_dwordx3 v[148:150], v5, s[20:23], 0 offen offset:2048
    s_mov_b32 s20, s46
    s_mov_b32 s21, s47
    buffer_load_dwordx4 v[152:155], v0, s[20:23], 0 offen
    buffer_load_dwordx4 v[156:159], v0, s[20:23], 0 offen offset:1024
    buffer_load_dwordx3 v[160:162], v5, s[20:23], 0 offen offset:2048
    s_mov_b32 s20, s48
    s_mov_b32 s21, s49
    buffer_load_dwordx4 v[164:167], v0, s[20:23], 0 offen
    buffer_load_dwordx4 v[168:171], v0, s[20:23], 0 offen offset:1024
    buffer_load_dwordx3 v[172:174], v5, s[20:23], 0 offen offset:2048
    s_mov_b32 s20, s50
    s_mov_b32 s21, s51
    s_mov_b32 s22, 2
    v_mov_b32 v6, 0
    buffer_load_ushort v176, v6, s[20:23], 0 offen
    s_mov_b32 s44, s40
    s_mov_b32 s45, s41
    s_mov_b32 s46, 0x400000
    s_mov_b32 s47, 0x20000
    v_lshrrev_b32 v5, 1, v4
    s_waitcnt vmcnt(9)
    buffer_load_dwordx4 a[36:39], v1, s[8:11], s66 offen offset:128 nt
    v_lshlrev_b32_e64 v5, 10, v5
    v_and_b32_e64 v6, 1, v4
    v_lshl_add_u32 v5, v6, 7, v5
    s_mov_b32 exec_lo, 0xffffffff
    s_mov_b32 exec_hi, 0x0
    buffer_load_dword v178, v5, s[44:47], s33 offen
    s_mov_b64 exec, -1
    s_waitcnt vmcnt(9)
    buffer_load_dwordx4 a[40:43], v1, s[8:11], s66 offen offset:2048 nt
    s_waitcnt vmcnt(9)
    buffer_load_dwordx4 a[44:47], v1, s[8:11], s66 offen offset:2176 nt
    s_waitcnt vmcnt(9)
    buffer_load_dwordx4 a[48:51], v1, s[8:11], s67 offen offset:0 nt
    s_waitcnt vmcnt(9)
    buffer_load_dwordx4 a[52:55], v1, s[8:11], s67 offen offset:128 nt
    s_waitcnt vmcnt(6)
    s_cmp_lg_u32 s3, 0
    s_cbranch_scc1 L_w_61
    v_readfirstlane_b32 s27, v179
    s_mul_i32 s35, s27, 0x9e3779b1
    s_add_u32 s35, s35, 0x7f4a7c15
    s_cmp_eq_u32 s35, s27
    s_addc_u32 s35, s35, 0
    s_getreg_b32 s25, hwreg(HW_REG_XCC_ID, 0, 4)
    s_not_b32 s27, s35
    s_xor_b32 s25, s25, s27
    v_mov_b32 v6, s35
    v_mov_b32 v7, s25
    v_mov_b32 v5, 0
    s_lshl_b32 s27, s4, 9
    s_lshl_b32 s28, s5, 4
    s_add_u32 s27, s27, s28
    s_add_u32 s27, s27, 2113536
    s_mov_b32 exec_lo, 1
    s_mov_b32 exec_hi, 0
    buffer_store_dwordx2 v[6:7], v5, s[16:19], s27 offen sc1
    s_mov_b64 exec, -1
L_w_61:
    v_lshlrev_b32 v64, 16, v140
    s_waitcnt vmcnt(9)
    buffer_load_dwordx4 a[56:59], v1, s[8:11], s67 offen offset:2048 nt
    v_and_b32 v65, 0xffff0000, v140
    v_lshlrev_b32 v66, 16, v141
    v_and_b32 v67, 0xffff0000, v141
    v_lshlrev_b32 v68, 16, v142
    v_and_b32 v69, 0xffff0000, v142
    v_lshlrev_b32 v70, 16, v143
    v_and_b32 v71, 0xffff0000, v143
    v_lshlrev_b32_e64 v72, 16, v144
    v_and_b32 v73, 0xffff0000, v144
    v_lshlrev_b32 v74, 16, v145
    v_and_b32 v75, 0xffff0000, v145
    v_lshlrev_b32 v76, 16, v146
    v_and_b32 v77, 0xffff0000, v146
    v_lshlrev_b32 v78, 16, v147
    v_and_b32 v79, 0xffff0000, v147
    v_lshlrev_b32 v80, 16, v148
    v_and_b32 v81, 0xffff0000, v148
    v_lshlrev_b32_e64 v82, 16, v149
    v_and_b32 v83, 0xffff0000, v149
    v_lshlrev_b32 v84, 16, v150
    v_and_b32 v85, 0xffff0000, v150
    v_lshlrev_b32 v86, 16, v152
    v_and_b32 v87, 0xffff0000, v152
    v_lshlrev_b32 v88, 16, v153
    s_waitcnt vmcnt(9)
    buffer_load_dwordx4 a[60:63], v1, s[8:11], s67 offen offset:2176 nt
    v_and_b32 v89, 0xffff0000, v153
    v_lshlrev_b32_e64 v90, 16, v154
    v_and_b32 v91, 0xffff0000, v154
    v_lshlrev_b32 v92, 16, v155
    v_and_b32 v93, 0xffff0000, v155
    v_lshlrev_b32 v94, 16, v156
    v_and_b32 v95, 0xffff0000, v156
    v_lshlrev_b32 v96, 16, v157
    v_and_b32 v97, 0xffff0000, v157
    v_lshlrev_b32 v98, 16, v158
    v_and_b32 v99, 0xffff0000, v158
    v_lshlrev_b32_e64 v100, 16, v159
    v_and_b32 v101, 0xffff0000, v159
    v_lshlrev_b32 v102, 16, v160
    v_and_b32 v103, 0xffff0000, v160
    v_lshlrev_b32 v104, 16, v161
    v_and_b32 v105, 0xffff0000, v161
    v_lshlrev_b32 v106, 16, v162
    v_and_b32 v107, 0xffff0000, v162
    v_lshlrev_b32 v108, 16, v164
    v_and_b32 v109, 0xffff0000, v164
    v_lshlrev_b32_e64 v110, 16, v165
    v_and_b32 v111, 0xffff0000, v165
    v_lshlrev_b32 v112, 16, v166
    s_waitcnt vmcnt(9)
    buffer_load_dwordx4 a[64:67], v1, s[8:11], s68 offen offset:0 nt
    v_and_b32 v113, 0xffff0000, v166
    v_lshlrev_b32 v114, 16, v167
    v_and_b32 v115, 0xffff0000, v167
    v_lshlrev_b32 v116, 16, v168
    v_and_b32 v117, 0xffff0000, v168
    v_lshlrev_b32_e64 v118, 16, v169
    v_and_b32 v119, 0xffff0000, v169
    v_lshlrev_b32 v120, 16, v170
    v_and_b32 v121, 0xffff0000, v170
    v_lshlrev_b32 v122, 16, v171
    v_and_b32 v123, 0xffff0000, v171
    v_lshlrev_b32_e64 v124, 16, v172
    v_and_b32 v125, 0xffff0000, v172
    v_lshlrev_b32_e64 v126, 16, v173
    v_and_b32 v127, 0xffff0000, v173
    v_lshlrev_b32_e64 v128, 16, v174
    v_and_b32 v129, 0xffff0000, v174
    v_mov_b32 v130, 0xc0135761
    v_mov_b32_e64 v132, 1.0
    v_lshlrev_b32 v176, 16, v176
    s_mov_b32 s62, 0xbdd2d3e8
    s_mov_b32 s63, s62
    s_lshl_b32 s36, s31, 3
    s_add_u32 s36, s36, s4
    s_lshl_b32 s36, s36, 6
    s_lshl_b32 s27, s3, 4
    s_add_u32 s36, s36, s27
    s_lshl_b32 s42, s36, 1
    s_add_u32 s42, s42, 2097152
    s_waitcnt vmcnt(9)
    buffer_load_dwordx4 a[68:71], v1, s[8:11], s68 offen offset:128 nt
    s_waitcnt vmcnt(9)
    buffer_load_dwordx4 a[72:75], v1, s[8:11], s68 offen offset:2048 nt
    s_waitcnt vmcnt(9)
    buffer_load_dwordx4 a[76:79], v1, s[8:11], s68 offen offset:2176 nt
    s_call_b64 s[58:59], L_tab
    v_add_f32 v16, v134, v135
    s_waitcnt vmcnt(9)
    buffer_load_dwordx4 a[80:83], v1, s[8:11], s69 offen offset:0 nt
    s_waitcnt vmcnt(9)
    buffer_load_dwordx4 a[84:87], v1, s[8:11], s69 offen offset:128 nt
    s_call_b64 s[58:59], L_tab
    v_add_f32 v17, v134, v135
    s_waitcnt vmcnt(9)
    buffer_load_dwordx4 a[88:91], v1, s[8:11], s69 offen offset:2048 nt
    s_waitcnt vmcnt(9)
    buffer_load_dwordx4 a[92:95], v1, s[8:11], s69 offen offset:2176 nt
    s_waitcnt vmcnt(9)
    buffer_load_dwordx4 a[96:99], v1, s[8:11], s70 offen offset:0 nt
    s_call_b64 s[58:59], L_tab
    v_add_f32 v18, v134, v135
    s_waitcnt vmcnt(9)
    buffer_load_dwordx4 a[100:103], v1, s[8:11], s70 offen offset:128 nt
    s_waitcnt vmcnt(9)
    buffer_load_dwordx4 a[104:107], v1, s[8:11], s70 offen offset:2048 nt
    s_call_b64 s[58:59], L_tab
    v_add_f32 v19, v134, v135
    s_waitcnt vmcnt(9)
    buffer_load_dwordx4 a[108:111], v1, s[8:11], s70 offen offset:2176 nt
    s_waitcnt vmcnt(9)
    buffer_load_dwordx4 a[112:115], v1, s[8:11], s71 offen offset:0 nt
    s_waitcnt vmcnt(9)
    buffer_load_dwordx4 a[116:119], v1, s[8:11], s71 offen offset:128 nt
    s_call_b64 s[58:59], L_tab
    v_add_f32 v20, v134, v135
    s_waitcnt vmcnt(9)
    buffer_load_dwordx4 a[120:123], v1, s[8:11], s71 offen offset:2048 nt
    s_waitcnt vmcnt(9)
    buffer_load_dwordx4 a[124:127], v1, s[8:11], s71 offen offset:2176 nt
    s_call_b64 s[58:59], L_tab
    v_add_f32 v21, v134, v135
    s_waitcnt vmcnt(9)
    buffer_load_dwordx4 a[128:131], v1, s[8:11], s72 offen offset:0 nt
    s_waitcnt vmcnt(9)
    buffer_load_dwordx4 a[132:135], v1, s[8:11], s72 offen offset:128 nt
    s_waitcnt vmcnt(9)
    buffer_load_dwordx4 a[136:139], v1, s[8:11], s72 offen offset:2048 nt
    s_call_b64 s[58:59], L_tab
    v_add_f32 v22, v134, v135
    s_waitcnt vmcnt(9)
    buffer_load_dwordx4 a[140:143], v1, s[8:11], s72 offen offset:2176 nt
    s_waitcnt vmcnt(9)
    buffer_load_dwordx4 a[144:147], v1, s[8:11], s73 offen offset:0 nt
    s_call_b64 s[58:59], L_tab
    v_add_f32 v23, v134, v135
    v_permlane32_swap_b32 v16, v20
    v_permlane32_swap_b32 v17, v21
    v_permlane32_swap_b32 v18, v22
    v_permlane32_swap_b32 v19, v23
    v_add_f32 v16, v16, v20
    v_add_f32 v17, v17, v21
    v_add_f32 v18, v18, v22
    v_add_f32 v19, v19, v23
    s_nop 0
    v_permlane16_swap_b32 v16, v18
    v_permlane16_swap_b32 v17, v19
    v_add_f32 v16, v16, v18
    v_add_f32 v17, v17, v19
    s_nop 0
    v_add_f32_dpp v16, v16, v16 row_ror:1 row_mask:0xf bank_mask:0xf
    s_nop 1
    v_add_f32_dpp v16, v16, v16 row_ror:2 row_mask:0xf bank_mask:0xf
    s_nop 1
    v_add_f32_dpp v16, v16, v16 row_ror:4 row_mask:0xf bank_mask:0xf
    s_nop 0
    s_nop 0
    v_add_f32_dpp v16, v16, v16 row_ror:8 row_mask:0xf bank_mask:0xf
    v_add_f32_dpp v17, v17, v17 row_ror:1 row_mask:0xf bank_mask:0xf
    s_nop 1
    v_add_f32_dpp v17, v17, v17 row_ror:2 row_mask:0xf bank_mask:0xf
    s_nop 1
    v_add_f32_dpp v17, v17, v17 row_ror:4 row_mask:0xf bank_mask:0xf
    s_nop 1
    v_add_f32_dpp v17, v17, v17 row_ror:8 row_mask:0xf bank_mask:0xf
    v_add_f32 v16, v16, v176
    v_add_f32_e64 v17, v17, v176
    v_cvt_pk_bf16_f32 v24, v16, v17
    v_min_u32 v24, -2, v24
    v_and_b32 v5, 0x1f0, v0
    s_lshl_b32 s29, s4, 9
    s_add_u32 s29, s29, 2113536
    s_cmp_lg_u32 s3, 0
    s_cbranch_scc1 L_w_64
    buffer_load_dwordx2 v[6:7], v5, s[16:19], s29 offen sc1
L_w_64:
    s_waitcnt vmcnt(9)
    buffer_load_dwordx4 a[148:151], v1, s[8:11], s73 offen offset:128 nt
    s_waitcnt vmcnt(9)
    buffer_load_dwordx4 a[152:155], v1, s[8:11], s73 offen offset:2048 nt
    s_waitcnt vmcnt(9)
    buffer_load_dwordx4 a[156:159], v1, s[8:11], s73 offen offset:2176 nt
    s_waitcnt vmcnt(9)
    buffer_load_dwordx4 a[160:163], v1, s[8:11], s74 offen offset:0 nt
    s_waitcnt vmcnt(4)
    s_cmp_lg_u32 s3, 0
    s_cbranch_scc1 L_w_65
L_gbc_63:
    v_xor_b32 v10, s25, v7
    v_xor_b32_e64 v11, s35, v6
    v_lshrrev_b32_e64 v12, 4, v10
    v_or_b32 v11, v11, v12
    v_cmp_ne_u32_e64 vcc, 0, v11
    s_cbranch_vccnz L_gbr_62
    v_cmp_ne_u32_e64 vcc, 0, v10
    s_cmp_eq_u64 vcc, 0
    s_cselect_b32 s25, 1, 0
    v_mov_b32_e64 v10, s25
    v_mov_b32_e64 v11, s35
    v_mov_b32_e64 v7, 0
    ds_write_b64 v7, v[10:11] offset:2368
    s_waitcnt lgkmcnt(0)
L_w_65:
    s_barrier
    v_mov_b32_e64 v7, 0
    ds_read_b64 v[10:11], v7 offset:2368
    s_waitcnt lgkmcnt(0)
    v_readfirstlane_b32 s25, v10
    v_readfirstlane_b32 s35, v11
    s_waitcnt vmcnt(9)
    buffer_load_dwordx4 a[164:167], v1, s[8:11], s74 offen offset:128 nt
    s_waitcnt vmcnt(9)
    buffer_load_dwordx4 a[168:171], v1, s[8:11], s74 offen offset:2048 nt
    s_waitcnt vmcnt(9)
    buffer_load_dwordx4 a[172:175], v1, s[8:11], s74 offen offset:2176 nt
    s_call_b64 s[58:59], L_tab
    v_add_f32 v16, v134, v135
    s_waitcnt vmcnt(9)
    buffer_load_dwordx4 a[176:179], v1, s[8:11], s75 offen offset:0 nt
    s_waitcnt vmcnt(9)
    buffer_load_dwordx4 a[180:183], v1, s[8:11], s75 offen offset:128 nt
    s_call_b64 s[58:59], L_tab
    v_add_f32 v17, v134, v135
    s_waitcnt vmcnt(9)
    buffer_load_dwordx4 a[184:187], v1, s[8:11], s75 offen offset:2048 nt
    s_waitcnt vmcnt(9)
    buffer_load_dwordx4 a[188:191], v1, s[8:11], s75 offen offset:2176 nt
    s_waitcnt vmcnt(9)
    buffer_load_dwordx4 a[192:195], v1, s[8:11], s76 offen offset:0 nt
    s_call_b64 s[58:59], L_tab
    v_add_f32 v18, v134, v135
    s_waitcnt vmcnt(9)
    buffer_load_dwordx4 a[196:199], v1, s[8:11], s76 offen offset:128 nt
    s_waitcnt vmcnt(9)
    buffer_load_dwordx4 a[200:203], v1, s[8:11], s76 offen offset:2048 nt
    s_call_b64 s[58:59], L_tab
    v_add_f32 v19, v134, v135
    s_waitcnt vmcnt(9)
    buffer_load_dwordx4 a[204:207], v1, s[8:11], s76 offen offset:2176 nt
    s_waitcnt vmcnt(9)
    buffer_load_dwordx4 a[208:211], v1, s[8:11], s77 offen offset:0 nt
    s_waitcnt vmcnt(9)
    buffer_load_dwordx4 a[212:215], v1, s[8:11], s77 offen offset:128 nt
    s_call_b64 s[58:59], L_tab
    v_add_f32 v20, v134, v135
    s_waitcnt vmcnt(9)
    buffer_load_dwordx4 a[216:219], v1, s[8:11], s77 offen offset:2048 nt
    s_waitcnt vmcnt(9)
    buffer_load_dwordx4 a[220:223], v1, s[8:11], s77 offen offset:2176 nt
    s_call_b64 s[58:59], L_tab
    v_add_f32 v21, v134, v135
    s_waitcnt vmcnt(9)
    buffer_load_dwordx4 a[224:227], v1, s[8:11], s78 offen offset:0 nt
    s_waitcnt vmcnt(9)
    buffer_load_dwordx4 a[228:231], v1, s[8:11], s78 offen offset:128 nt
    s_waitcnt vmcnt(9)
    buffer_load_dwordx4 a[232:235], v1, s[8:11], s78 offen offset:2048 nt
    s_call_b64 s[58:59], L_tab
    v_add_f32 v22, v134, v135
    s_waitcnt vmcnt(9)
    buffer_load_dwordx4 a[236:239], v1, s[8:11], s78 offen offset:2176 nt
    s_waitcnt vmcnt(9)
    buffer_load_dwordx4 a[240:243], v1, s[8:11], s79 offen offset:0 nt
    s_call_b64 s[58:59], L_tab
    v_add_f32 v23, v134, v135
    v_permlane32_swap_b32 v16, v20
    v_permlane32_swap_b32 v17, v21
    v_permlane32_swap_b32 v18, v22
    v_permlane32_swap_b32 v19, v23
    v_add_f32 v16, v16, v20
    v_add_f32 v17, v17, v21
    v_add_f32 v18, v18, v22
    v_add_f32 v19, v19, v23
    s_nop 0
    v_permlane16_swap_b32 v16, v18
    v_permlane16_swap_b32 v17, v19
    v_add_f32 v16, v16, v18
    v_add_f32 v17, v17, v19
    s_nop 0
    v_add_f32_dpp v16, v16, v16 row_ror:1 row_mask:0xf bank_mask:0xf
    s_nop 1
    v_add_f32_dpp v16, v16, v16 row_ror:2 row_mask:0xf bank_mask:0xf
    s_nop 1
    v_add_f32_dpp v16, v16, v16 row_ror:4 row_mask:0xf bank_mask:0xf
    s_nop 1
    v_add_f32_dpp v16, v16, v16 row_ror:8 row_mask:0xf bank_mask:0xf
    v_add_f32_dpp v17, v17, v17 row_ror:1 row_mask:0xf bank_mask:0xf
    s_nop 1
    v_add_f32_dpp v17, v17, v17 row_ror:2 row_mask:0xf bank_mask:0xf
    s_nop 1
    v_add_f32_dpp v17, v17, v17 row_ror:4 row_mask:0xf bank_mask:0xf
    s_nop 0
    s_nop 0
    v_add_f32_dpp v17, v17, v17 row_ror:8 row_mask:0xf bank_mask:0xf
    v_add_f32 v16, v16, v176
    v_add_f32 v17, v17, v176
    v_cvt_pk_bf16_f32 v25, v16, v17
    v_min_u32 v25, -2, v25
    v_lshrrev_b32 v9, 6, v0
    s_mov_b32 exec_lo, 65537
    s_mov_b32 exec_hi, 65537
    buffer_store_dword v24, v9, s[16:19], s42 offen sc1
    buffer_store_dword v25, v9, s[16:19], s42 offen offset:16 sc1
    s_mov_b64 exec, -1
    s_waitcnt vmcnt(9)
    buffer_load_dwordx4 a[244:247], v1, s[8:11], s79 offen offset:128 nt
    s_waitcnt vmcnt(9)
    buffer_load_dwordx4 a[248:251], v1, s[8:11], s79 offen offset:2048 nt
    s_waitcnt vmcnt(9)
    buffer_load_dwordx4 a[252:255], v1, s[8:11], s79 offen offset:2176 nt
    s_branch L_pass1
L_tab:
    s_and_b32 s27, s36, 0xfff
    s_add_u32 s28, s27, 12800
    s_cmp_eq_u32 s27, 0
    s_cselect_b32 s28, 0, s28
    s_lshr_b32 s27, s36, 12
    s_lshl_b32 s27, s27, 15
    s_add_u32 s28, s28, s27
    s_lshl_b32 s96, s28, 16
    s_mov_b32 s97, s96
    s_add_u32 s36, s36, 1
    v_mov_b64 v[134:135], 0
    v_pk_fma_f32 v[200:201], v[64:65], s[96:97], v[86:87]
    v_pk_fma_f32 v[204:205], v[66:67], s[96:97], v[88:89]
    v_pk_fma_f32 v[208:209], v[68:69], s[96:97], v[90:91]
    v_pk_mul_f32 v[202:203], v[200:201], v[200:201]
    v_pk_mul_f32 v[206:207], v[204:205], v[204:205]
    v_pk_mul_f32 v[210:211], v[208:209], v[208:209]
    v_pk_fma_f32 v[202:203], v[202:203], s[62:63], v[130:131] op_sel_hi:[1,1,0]
    v_pk_fma_f32 v[206:207], v[206:207], s[62:63], v[130:131] op_sel_hi:[1,1,0]
    v_pk_fma_f32 v[210:211], v[210:211], s[62:63], v[130:131] op_sel_hi:[1,1,0]
    v_pk_mul_f32 v[202:203], v[202:203], v[200:201]
    v_pk_mul_f32 v[206:207], v[206:207], v[204:205]
    v_pk_mul_f32 v[210:211], v[210:211], v[208:209]
    v_exp_f32 v202, v202
    v_exp_f32 v203, v203
    v_exp_f32 v206, v206
    v_exp_f32 v207, v207
    v_exp_f32 v210, v210
    v_exp_f32 v211, v211
    v_pk_mul_f32 v[200:201], v[200:201], v[108:109]
    v_pk_mul_f32 v[204:205], v[204:205], v[110:111]
    v_pk_mul_f32 v[208:209], v[208:209], v[112:113]
    v_pk_add_f32 v[202:203], v[202:203], v[132:133] op_sel_hi:[1,0]
    v_pk_add_f32 v[206:207], v[206:207], v[132:133] op_sel_hi:[1,0]
    v_pk_add_f32 v[210:211], v[210:211], v[132:133] op_sel_hi:[1,0]
    v_rcp_f32 v202, v202
    v_rcp_f32 v203, v203
    v_rcp_f32 v206, v206
    v_rcp_f32 v207, v207
    v_rcp_f32 v210, v210
    v_rcp_f32 v211, v211
    v_pk_fma_f32 v[134:135], v[200:201], v[202:203], v[134:135]
    v_pk_fma_f32 v[134:135], v[204:205], v[206:207], v[134:135]
    v_pk_fma_f32 v[134:135], v[208:209], v[210:211], v[134:135]
    v_pk_fma_f32 v[200:201], v[70:71], s[96:97], v[92:93]
    v_pk_fma_f32 v[204:205], v[72:73], s[96:97], v[94:95]
    v_pk_fma_f32 v[208:209], v[74:75], s[96:97], v[96:97]
    v_pk_mul_f32 v[202:203], v[200:201], v[200:201]
    v_pk_mul_f32 v[206:207], v[204:205], v[204:205]
    v_pk_mul_f32 v[210:211], v[208:209], v[208:209]
    v_pk_fma_f32 v[202:203], v[202:203], s[62:63], v[130:131] op_sel_hi:[1,1,0]
    v_pk_fma_f32 v[206:207], v[206:207], s[62:63], v[130:131] op_sel_hi:[1,1,0]
    v_pk_fma_f32 v[210:211], v[210:211], s[62:63], v[130:131] op_sel_hi:[1,1,0]
    v_pk_mul_f32 v[202:203], v[202:203], v[200:201]
    v_pk_mul_f32 v[206:207], v[206:207], v[204:205]
    v_pk_mul_f32 v[210:211], v[210:211], v[208:209]
    v_exp_f32 v202, v202
    v_exp_f32 v203, v203
    v_exp_f32 v206, v206
    v_exp_f32 v207, v207
    v_exp_f32 v210, v210
    v_exp_f32 v211, v211
    v_pk_mul_f32 v[200:201], v[200:201], v[114:115]
    v_pk_mul_f32 v[204:205], v[204:205], v[116:117]
    v_pk_mul_f32 v[208:209], v[208:209], v[118:119]
    v_pk_add_f32 v[202:203], v[202:203], v[132:133] op_sel_hi:[1,0]
    v_pk_add_f32 v[206:207], v[206:207], v[132:133] op_sel_hi:[1,0]
    v_pk_add_f32 v[210:211], v[210:211], v[132:133] op_sel_hi:[1,0]
    v_rcp_f32 v202, v202
    v_rcp_f32 v203, v203
    v_rcp_f32 v206, v206
    v_rcp_f32 v207, v207
    v_rcp_f32 v210, v210
    v_rcp_f32 v211, v211
    v_pk_fma_f32 v[134:135], v[200:201], v[202:203], v[134:135]
    v_pk_fma_f32 v[134:135], v[204:205], v[206:207], v[134:135]
    v_pk_fma_f32 v[134:135], v[208:209], v[210:211], v[134:135]
    v_pk_fma_f32 v[200:201], v[76:77], s[96:97], v[98:99]
    v_pk_fma_f32 v[204:205], v[78:79], s[96:97], v[100:101]
    v_pk_fma_f32 v[208:209], v[80:81], s[96:97], v[102:103]
    v_pk_mul_f32 v[202:203], v[200:201], v[200:201]
    v_pk_mul_f32 v[206:207], v[204:205], v[204:205]
    v_pk_mul_f32 v[210:211], v[208:209], v[208:209]
    v_pk_fma_f32 v[202:203], v[202:203], s[62:63], v[130:131] op_sel_hi:[1,1,0]
    v_pk_fma_f32 v[206:207], v[206:207], s[62:63], v[130:131] op_sel_hi:[1,1,0]
    v_pk_fma_f32 v[210:211], v[210:211], s[62:63], v[130:131] op_sel_hi:[1,1,0]
    v_pk_mul_f32 v[202:203], v[202:203], v[200:201]
    v_pk_mul_f32 v[206:207], v[206:207], v[204:205]
    v_pk_mul_f32 v[210:211], v[210:211], v[208:209]
    v_exp_f32 v202, v202
    v_exp_f32 v203, v203
    v_exp_f32 v206, v206
    v_exp_f32 v207, v207
    v_exp_f32 v210, v210
    v_exp_f32 v211, v211
    v_pk_mul_f32 v[200:201], v[200:201], v[120:121]
    v_pk_mul_f32 v[204:205], v[204:205], v[122:123]
    v_pk_mul_f32 v[208:209], v[208:209], v[124:125]
    v_pk_add_f32 v[202:203], v[202:203], v[132:133] op_sel_hi:[1,0]
    v_pk_add_f32 v[206:207], v[206:207], v[132:133] op_sel_hi:[1,0]
    v_pk_add_f32 v[210:211], v[210:211], v[132:133] op_sel_hi:[1,0]
    v_rcp_f32 v202, v202
    v_rcp_f32 v203, v203
    v_rcp_f32 v206, v206
    v_rcp_f32 v207, v207
    v_rcp_f32 v210, v210
    v_rcp_f32 v211, v211
    v_pk_fma_f32 v[134:135], v[200:201], v[202:203], v[134:135]
    v_pk_fma_f32 v[134:135], v[204:205], v[206:207], v[134:135]
    v_pk_fma_f32 v[134:135], v[208:209], v[210:211], v[134:135]
    v_pk_fma_f32 v[200:201], v[82:83], s[96:97], v[104:105]
    v_pk_fma_f32 v[204:205], v[84:85], s[96:97], v[106:107]
    v_pk_mul_f32 v[202:203], v[200:201], v[200:201]
    v_pk_mul_f32 v[206:207], v[204:205], v[204:205]
    v_pk_fma_f32 v[202:203], v[202:203], s[62:63], v[130:131] op_sel_hi:[1,1,0]
    v_pk_fma_f32 v[206:207], v[206:207], s[62:63], v[130:131] op_sel_hi:[1,1,0]
    v_pk_mul_f32 v[202:203], v[202:203], v[200:201]
    v_pk_mul_f32 v[206:207], v[206:207], v[204:205]
    v_exp_f32 v202, v202
    v_exp_f32 v203, v203
    v_exp_f32 v206, v206
    v_exp_f32 v207, v207
    v_pk_mul_f32 v[200:201], v[200:201], v[126:127]
    v_pk_mul_f32 v[204:205], v[204:205], v[128:129]
    v_pk_add_f32 v[202:203], v[202:203], v[132:133] op_sel_hi:[1,0]
    v_pk_add_f32 v[206:207], v[206:207], v[132:133] op_sel_hi:[1,0]
    v_rcp_f32 v202, v202
    v_rcp_f32 v203, v203
    v_rcp_f32 v206, v206
    v_rcp_f32_e64 v207, v207
    v_pk_fma_f32 v[134:135], v[200:201], v[202:203], v[134:135]
    v_pk_fma_f32 v[134:135], v[204:205], v[206:207], v[134:135]
    s_setpc_b64 s[58:59]
L_q1r_17:
    s_sub_u32 s26, s26, 1
    s_cbranch_scc1 L_fail
    s_mov_b64 exec, vcc
    buffer_load_dwordx4 v[8:11], v0, s[16:19], s95 offen offset:0 sc1
    buffer_load_dwordx4 v[12:15], v0, s[16:19], s95 offen offset:1024 sc1
    s_mov_b64 exec, -1
    s_branch L_q1w_15
L_tb0h_19:
    s_bitcmp1_b32 s7, 0
    s_cbranch_scc1 L_o_66
    s_lshl_b32 s28, s31, 8
    s_add_u32 s28, s28, 2121728
    v_bfe_u32 v24, v0, 4, 3
    v_lshlrev_b32 v24, 2, v24
    buffer_load_dword v25, v24, s[16:19], s28 offen sc1
L_o_66:
    s_branch L_tb0b_20
L_tb1h_21:
    s_bitcmp1_b32 s7, 0
    s_cbranch_scc1 L_o_67
L_grc_68:
    v_cmp_ne_u32_e64 vcc, s35, v25
    s_cbranch_vccnz L_grr_69
    s_add_u32 s27, s2, s3
    s_cmp_lg_u32 s27, 0
    s_cbranch_scc1 L_epo_70
    v_mov_b32 v24, 2129920
    s_mov_b32 exec_lo, 1
    s_mov_b32 exec_hi, 0
    buffer_store_dword v25, v24, s[16:19], 0 offen sc1
    s_mov_b64 exec, -1
L_epo_70:
    s_lshl_b32 s28, s3, 12
    s_add_u32 s28, s28, 2097152
    buffer_load_dwordx4 v[48:51], v0, s[16:19], s28 offen offset:0 sc1
    buffer_load_dwordx4 v[52:55], v0, s[16:19], s28 offen offset:1024 sc1
    buffer_load_dwordx4 v[56:59], v0, s[16:19], s28 offen offset:2048 sc1
    buffer_load_dwordx4 v[60:63], v0, s[16:19], s28 offen offset:3072 sc1
L_o_67:
    s_branch L_tb1b_22
L_tb2h_23:
    s_bitcmp1_b32 s7, 0
    s_cbranch_scc1 L_o_71
L_tbc_72:
    v_max3_u32 v26, v48, v49, v50
    v_max3_u32 v26, v26, v51, v52
    v_max3_u32 v26, v26, v53, v54
    v_max3_u32 v26, v26, v55, v56
    v_max3_u32 v26, v26, v57, v58
    v_max3_u32 v26, v26, v59, v60
    v_max3_u32 v26, v26, v61, v62
    v_max_u32 v26, v26, v63
    v_cmp_eq_u32 vcc, -1, v26
    s_cbranch_vccnz L_tbr_73
    s_lshl_b32 s29, s3, 12
    v_add_u32 v26, s29, v0
    ds_write_b128 v26, v[48:51] offset:4096
    ds_write_b128 v26, v[52:55] offset:5120
    ds_write_b128 v26, v[56:59] offset:6144
    ds_write_b128 v26, v[60:63] offset:7168
L_o_71:
    s_branch L_tb2b_24
L_hqh_25:
    s_bitcmp1_b32 s7, 0
    s_cbranch_scc1 L_ko_74
    buffer_load_dwordx4 a[12:15], v1, s[8:11], s64 offen offset:2176 nt
    buffer_load_dwordx4 a[16:19], v1, s[8:11], s65 offen offset:0 nt
    buffer_load_dwordx4 a[20:23], v1, s[8:11], s65 offen offset:128 nt
    buffer_load_dwordx4 a[24:27], v1, s[8:11], s65 offen offset:2048 nt
    s_branch L_kj_75
L_ko_74:
    buffer_load_dwordx4 a[32:35], v1, s[8:11], s66 offen offset:0 nt
    buffer_load_dwordx4 a[36:39], v1, s[8:11], s66 offen offset:128 nt
    buffer_load_dwordx4 a[40:43], v1, s[8:11], s66 offen offset:2048 nt
    buffer_load_dwordx4 a[44:47], v1, s[8:11], s66 offen offset:2176 nt
L_kj_75:
    s_branch L_hqb_26
L_hph_27:
    s_bitcmp1_b32 s7, 0
    s_cbranch_scc1 L_ko_76
    s_waitcnt vmcnt(11)
    buffer_load_dwordx4 a[28:31], v1, s[8:11], s65 offen offset:2176 nt
    s_waitcnt vmcnt(11)
    buffer_load_dwordx4 a[176:179], v1, s[8:11], s75 offen offset:0 nt
    s_waitcnt vmcnt(11)
    buffer_load_dwordx4 a[32:35], v1, s[8:11], s66 offen offset:0 nt
    s_waitcnt vmcnt(11)
    buffer_load_dwordx4 a[180:183], v1, s[8:11], s75 offen offset:128 nt
    s_waitcnt vmcnt(11)
    buffer_load_dwordx4 a[36:39], v1, s[8:11], s66 offen offset:128 nt
    s_branch L_kj_77
L_ko_76:
L_fl_78:
    s_cmp_ge_u32 s34, 8
    s_cbranch_scc1 L_fd_79
    s_call_b64 s[58:59], L_nxt
    s_branch L_fl_78
L_fd_79:
    s_waitcnt vmcnt(7)
    buffer_load_dwordx4 a[48:51], v1, s[8:11], s67 offen offset:0 nt
    s_waitcnt vmcnt(7)
    buffer_load_dwordx4 a[52:55], v1, s[8:11], s67 offen offset:128 nt
    s_waitcnt vmcnt(7)
    buffer_load_dwordx4 a[56:59], v1, s[8:11], s67 offen offset:2048 nt
    s_waitcnt vmcnt(7)
    buffer_load_dwordx4 a[60:63], v1, s[8:11], s67 offen offset:2176 nt
    s_waitcnt vmcnt(7)
    buffer_load_dwordx4 a[64:67], v1, s[8:11], s68 offen offset:0 nt
L_kj_77:
    s_branch L_hpb_28
L_hmh_29:
    s_bitcmp1_b32 s7, 0
    s_cbranch_scc1 L_ko_80
    s_waitcnt vmcnt(11)
    buffer_load_dwordx4 a[184:187], v1, s[8:11], s75 offen offset:2048 nt
    s_waitcnt vmcnt(11)
    buffer_load_dwordx4 a[40:43], v1, s[8:11], s66 offen offset:2048 nt
    s_waitcnt vmcnt(11)
    buffer_load_dwordx4 a[188:191], v1, s[8:11], s75 offen offset:2176 nt
    s_waitcnt vmcnt(11)
    buffer_load_dwordx4 a[44:47], v1, s[8:11], s66 offen offset:2176 nt
    s_waitcnt vmcnt(11)
    buffer_load_dwordx4 a[48:51], v1, s[8:11], s67 offen offset:0 nt
    s_waitcnt vmcnt(11)
    buffer_load_dwordx4 a[52:55], v1, s[8:11], s67 offen offset:128 nt
    s_waitcnt vmcnt(11)
    buffer_load_dwordx4 a[56:59], v1, s[8:11], s67 offen offset:2048 nt
    s_waitcnt vmcnt(11)
    buffer_load_dwordx4 a[60:63], v1, s[8:11], s67 offen offset:2176 nt
    s_branch L_kj_81
L_ko_80:
    s_waitcnt vmcnt(7)
    buffer_load_dwordx4 a[68:71], v1, s[8:11], s68 offen offset:128 nt
    s_waitcnt vmcnt(7)
    buffer_load_dwordx4 a[72:75], v1, s[8:11], s68 offen offset:2048 nt
    s_waitcnt vmcnt(7)
    buffer_load_dwordx4 a[76:79], v1, s[8:11], s68 offen offset:2176 nt
    s_waitcnt vmcnt(7)
    buffer_load_dwordx4 a[80:83], v1, s[8:11], s69 offen offset:0 nt
L_kj_81:
    s_branch L_hmb_30
L_heh_31:
    s_bitcmp1_b32 s7, 0
    s_cbranch_scc1 L_ko_82
    s_waitcnt vmcnt(11)
    buffer_load_dwordx4 a[192:195], v1, s[8:11], s76 offen offset:0 nt
    s_waitcnt vmcnt(11)
    buffer_load_dwordx4 a[64:67], v1, s[8:11], s68 offen offset:0 nt
    s_waitcnt vmcnt(11)
    buffer_load_dwordx4 a[196:199], v1, s[8:11], s76 offen offset:128 nt
    s_waitcnt vmcnt(11)
    buffer_load_dwordx4 a[68:71], v1, s[8:11], s68 offen offset:128 nt
    s_waitcnt vmcnt(11)
    buffer_load_dwordx4 a[200:203], v1, s[8:11], s76 offen offset:2048 nt
    s_waitcnt vmcnt(11)
    buffer_load_dwordx4 a[72:75], v1, s[8:11], s68 offen offset:2048 nt
    s_branch L_kj_83
L_ko_82:
    s_waitcnt vmcnt(7)
    buffer_load_dwordx4 a[84:87], v1, s[8:11], s69 offen offset:128 nt
    s_waitcnt vmcnt(7)
    buffer_load_dwordx4 a[88:91], v1, s[8:11], s69 offen offset:2048 nt
    s_waitcnt vmcnt(7)
    buffer_load_dwordx4 a[92:95], v1, s[8:11], s69 offen offset:2176 nt
L_kj_83:
    s_branch L_heb_32
L_slow_34:
    buffer_store_dword v10, v4, s[16:19], s89 offen sc1
    buffer_store_dword v11, v4, s[16:19], s89 offen offset:128 sc1
    s_mov_b32 exec_lo, 1
    s_mov_b32 exec_hi, 0
    buffer_store_dwordx2 v[44:45], v46, s[16:19], s89 offen sc1
    s_mov_b64 exec, -1
    s_branch L_slowb_35
L_Ar_38:
    s_sub_u32 s26, s26, 1
    s_cbranch_scc1 L_fail
    s_mov_b64 exec, vcc
    buffer_load_dwordx2 v[4:5], v6, s[16:19], s88 offen sc1
    buffer_load_dwordx4 v[8:11], v0, s[16:19], s88 offen offset:0 sc1
    buffer_load_dwordx4 v[12:15], v0, s[16:19], s88 offen offset:1024 sc1
    buffer_load_dwordx4 v[16:19], v0, s[16:19], s88 offen offset:2048 sc1
    buffer_load_dwordx4 v[20:23], v0, s[16:19], s88 offen offset:3072 sc1
    s_mov_b64 exec, -1
    s_branch L_Aw_36
L_Ah_39:
    s_waitcnt vmcnt(11)
    buffer_load_dwordx4 a[204:207], v1, s[8:11], s76 offen offset:2176 nt
    s_waitcnt vmcnt(11)
    buffer_load_dwordx4 a[76:79], v1, s[8:11], s68 offen offset:2176 nt
    s_waitcnt vmcnt(11)
    buffer_load_dwordx4 a[208:211], v1, s[8:11], s77 offen offset:0 nt
    s_waitcnt vmcnt(11)
    buffer_load_dwordx4 a[80:83], v1, s[8:11], s69 offen offset:0 nt
    s_waitcnt vmcnt(11)
    buffer_load_dwordx4 a[212:215], v1, s[8:11], s77 offen offset:128 nt
    s_waitcnt vmcnt(11)
    buffer_load_dwordx4 a[84:87], v1, s[8:11], s69 offen offset:128 nt
    s_waitcnt vmcnt(11)
    buffer_load_dwordx4 a[216:219], v1, s[8:11], s77 offen offset:2048 nt
    s_waitcnt vmcnt(11)
    buffer_load_dwordx4 a[88:91], v1, s[8:11], s69 offen offset:2048 nt
    s_waitcnt vmcnt(11)
    buffer_load_dwordx4 a[220:223], v1, s[8:11], s77 offen offset:2176 nt
    s_waitcnt vmcnt(11)
    buffer_load_dwordx4 a[92:95], v1, s[8:11], s69 offen offset:2176 nt
    s_waitcnt vmcnt(11)
    buffer_load_dwordx4 a[224:227], v1, s[8:11], s78 offen offset:0 nt
    s_waitcnt vmcnt(11)
    buffer_load_dwordx4 a[96:99], v1, s[8:11], s70 offen offset:0 nt
    s_waitcnt vmcnt(11)
    buffer_load_dwordx4 a[228:231], v1, s[8:11], s78 offen offset:128 nt
    s_waitcnt vmcnt(11)
    buffer_load_dwordx4 a[100:103], v1, s[8:11], s70 offen offset:128 nt
    s_waitcnt vmcnt(11)
    buffer_load_dwordx4 a[232:235], v1, s[8:11], s78 offen offset:2048 nt
    s_waitcnt vmcnt(11)
    buffer_load_dwordx4 a[104:107], v1, s[8:11], s70 offen offset:2048 nt
    buffer_load_dwordx2 v[4:5], v6, s[16:19], s88 offen sc1
    buffer_load_dwordx4 v[8:11], v0, s[16:19], s88 offen offset:0 sc1
    buffer_load_dwordx4 v[12:15], v0, s[16:19], s88 offen offset:1024 sc1
    buffer_load_dwordx4 v[16:19], v0, s[16:19], s88 offen offset:2048 sc1
    buffer_load_dwordx4 v[20:23], v0, s[16:19], s88 offen offset:3072 sc1
    s_lshl_b32 s27, s3, 1
    v_bfe_u32 v46, v0, 6, 3
    v_xor_b32_e64 v46, s27, v46
    v_bfe_u32 v7, v0, 4, 2
    v_lshl_add_u32 v46, v46, 2, v7
    v_bfe_u32 v7, v0, 6, 2
    v_lshl_add_u32 v46, v7, 5, v46
    v_lshrrev_b32_e64 v7, 8, v0
    v_lshl_add_u32 v46, v7, 8, v46
    v_lshlrev_b32 v46, 3, v46
    v_add_u32 v46, 53248, v46
    v_xor_b32 v7, 32, v46
    ds_read_b64_tr_b16 v[24:25], v46 offset:0
    ds_read_b64_tr_b16 v[26:27], v46 offset:1024
    ds_read_b64_tr_b16 v[28:29], v46 offset:8192
    ds_read_b64_tr_b16 v[30:31], v46 offset:9216
    ds_read_b64_tr_b16 v[32:33], v46 offset:16384
    ds_read_b64_tr_b16 v[34:35], v46 offset:17408
    ds_read_b64_tr_b16 v[36:37], v46 offset:24576
    ds_read_b64_tr_b16 v[38:39], v46 offset:25600
    ds_read_b64_tr_b16 v[48:49], v7 offset:0
    ds_read_b64_tr_b16 v[50:51], v7 offset:1024
    ds_read_b64_tr_b16 v[52:53], v7 offset:8192
    ds_read_b64_tr_b16 v[54:55], v7 offset:9216
    ds_read_b64_tr_b16 v[56:57], v7 offset:16384
    ds_read_b64_tr_b16 v[58:59], v7 offset:17408
    ds_read_b64_tr_b16 v[60:61], v7 offset:24576
    ds_read_b64_tr_b16 v[62:63], v7 offset:25600
    v_lshrrev_b32 v7, 2, v0
    s_waitcnt vmcnt(11)
    buffer_load_dwordx4 a[236:239], v1, s[8:11], s78 offen offset:2176 nt
    s_waitcnt vmcnt(11)
    buffer_load_dwordx4 a[108:111], v1, s[8:11], s70 offen offset:2176 nt
    s_waitcnt vmcnt(11)
    buffer_load_dwordx4 a[240:243], v1, s[8:11], s79 offen offset:0 nt
    s_waitcnt vmcnt(11)
    buffer_load_dwordx4 a[112:115], v1, s[8:11], s71 offen offset:0 nt
    s_waitcnt vmcnt(11)
    buffer_load_dwordx4 a[244:247], v1, s[8:11], s79 offen offset:128 nt
    s_waitcnt vmcnt(11)
    buffer_load_dwordx4 a[116:119], v1, s[8:11], s71 offen offset:128 nt
    s_waitcnt vmcnt(11)
    buffer_load_dwordx4 a[248:251], v1, s[8:11], s79 offen offset:2048 nt
    s_waitcnt vmcnt(11)
    buffer_load_dwordx4 a[120:123], v1, s[8:11], s71 offen offset:2048 nt
    s_waitcnt vmcnt(8)
    s_branch L_Ac_37
L_Br_44:
    s_sub_u32 s26, s26, 1
    s_cbranch_scc1 L_fail
    s_mov_b64 exec, vcc
    buffer_load_dwordx4 v[8:11], v0, s[16:19], s91 offen offset:0 sc1
    buffer_load_dwordx4 v[12:15], v0, s[16:19], s91 offen offset:1024 sc1
    buffer_load_dwordx4 v[16:19], v0, s[16:19], s91 offen offset:2048 sc1
    buffer_load_dwordx4 v[20:23], v0, s[16:19], s91 offen offset:3072 sc1
    s_mov_b64 exec, -1
    s_branch L_Bw_42
L_slow_46:
    buffer_store_dword v8, v6, s[16:19], s92 offen sc1
    s_branch L_slowb_47
L_Bo_41:
    s_cmp_eq_u32 s3, 2
    s_cselect_b32 s27, s95, s88
    s_cmp_eq_u32 s3, 1
    s_cselect_b32 s27, s93, s27
    s_cselect_b32 s28, 0x3800, 0
    v_lshlrev_b32 v6, 3, v0
    v_bfe_u32 v7, v0, 8, 1
    v_mad_u32_u24 v6, v7, s28, v6
    s_cmp_eq_u32 s3, 2
    s_cselect_b32 exec_lo, 0xffff, -1
    s_cselect_b32 exec_hi, 0, 1
    buffer_load_dword v44, v6, s[16:19], s27 offen sc1
    s_mov_b64 exec, -1
    s_branch L_B2_40
L_fin1:
    s_cmp_eq_u32 s5, 0
    s_cbranch_scc1 L_B2_40
    s_branch L_exit
L_Xr_50:
    s_sub_u32 s26, s26, 1
    s_cbranch_scc1 L_fail
    s_mov_b64 exec, vcc
    buffer_load_dwordx4 v[8:11], v5, s[16:19], s93 offen sc1
    buffer_load_dwordx4 v[12:15], v5, s[16:19], s93 offen offset:1024 sc1
    s_mov_b64 exec, -1
    s_branch L_Xw_48
L_tiny:
    s_load_dwordx8 s[44:51], s[0:1], 48
    s_waitcnt lgkmcnt(0)
    v_bfe_u32 v44, v4, 0, 15
    v_cmp_lt_u32 vcc, 0x41ff, v44
    s_mov_b64 s[96:97], vcc
    v_add_u32_e64 v44, -1, v44
    v_cmp_gt_u32 vcc, 0x3200, v44
    s_or_b64 s[96:97], s[96:97], vcc
L_tl_84:
    s_cmp_eq_u64 s[96:97], 0
    s_cbranch_scc1 L_td_85
    s_ff1_i32_b64 s98, s[96:97]
    s_bitset0_b64 s[96:97], s98
    v_readlane_b32 s99, v4, s98
    s_lshl_b32 s99, s99, 16
    s_call_b64 s[58:59], L_eval
    s_mov_b32 m0, s98
    s_nop 0
    s_nop 0
    v_writelane_b32 v16, s101, m0
    s_branch L_tl_84
L_td_85:
    v_bfe_u32 v44, v4, 16, 15
    v_cmp_lt_u32 vcc, 0x41ff, v44
    s_mov_b64 s[96:97], vcc
    v_add_u32_e64 v44, -1, v44
    v_cmp_gt_u32 vcc, 0x3200, v44
    s_or_b64 s[96:97], s[96:97], vcc
L_tl_86:
    s_cmp_eq_u64 s[96:97], 0
    s_cbranch_scc1 L_td_87
    s_ff1_i32_b64 s98, s[96:97]
    s_bitset0_b64 s[96:97], s98
    v_readlane_b32 s99, v4, s98
    s_and_b32 s99, s99, 0xffff0000
    s_call_b64 s[58:59], L_eval
    s_mov_b32 m0, s98
    s_nop 0
    s_nop 0
    v_writelane_b32 v17, s101, m0
    s_branch L_tl_86
L_td_87:
    v_bfe_u32 v44, v5, 0, 15
    v_cmp_lt_u32 vcc, 0x41ff, v44
    s_mov_b64 s[96:97], vcc
    v_add_u32_e64 v44, -1, v44
    v_cmp_gt_u32 vcc, 0x3200, v44
    s_or_b64 s[96:97], s[96:97], vcc
L_tl_88:
    s_cmp_eq_u64 s[96:97], 0
    s_cbranch_scc1 L_td_89
    s_ff1_i32_b64 s98, s[96:97]
    s_bitset0_b64 s[96:97], s98
    v_readlane_b32 s99, v5, s98
    s_lshl_b32 s99, s99, 16
    s_call_b64 s[58:59], L_eval
    s_mov_b32 m0, s98
    s_nop 0
    s_nop 0
    v_writelane_b32 v18, s101, m0
    s_branch L_tl_88
L_td_89:
    v_bfe_u32 v44, v5, 16, 15
    v_cmp_lt_u32 vcc, 0x41ff, v44
    s_mov_b64 s[96:97], vcc
    v_add_u32_e64 v44, -1, v44
    v_cmp_gt_u32 vcc, 0x3200, v44
    s_or_b64 s[96:97], s[96:97], vcc
L_tl_90:
    s_cmp_eq_u64 s[96:97], 0
    s_cbranch_scc1 L_td_91
    s_ff1_i32_b64 s98, s[96:97]
    s_bitset0_b64 s[96:97], s98
    v_readlane_b32 s99, v5, s98
    s_and_b32 s99, s99, 0xffff0000
    s_call_b64 s[58:59], L_eval
    s_mov_b32 m0, s98
    s_nop 1
    v_writelane_b32 v19, s101, m0
    s_branch L_tl_90
L_td_91:
    v_bfe_u32 v44, v6, 0, 15
    v_cmp_lt_u32 vcc, 0x41ff, v44
    s_mov_b64 s[96:97], vcc
    v_add_u32_e64 v44, -1, v44
    v_cmp_gt_u32 vcc, 0x3200, v44
    s_or_b64 s[96:97], s[96:97], vcc
L_tl_92:
    s_cmp_eq_u64 s[96:97], 0
    s_cbranch_scc1 L_td_93
    s_ff1_i32_b64 s98, s[96:97]
    s_bitset0_b64 s[96:97], s98
    v_readlane_b32 s99, v6, s98
    s_lshl_b32 s99, s99, 16
    s_call_b64 s[58:59], L_eval
    s_mov_b32 m0, s98
    s_nop 0
    s_nop 0
    v_writelane_b32 v20, s101, m0
    s_branch L_tl_92
L_td_93:
    v_bfe_u32 v44, v6, 16, 15
    v_cmp_lt_u32 vcc, 0x41ff, v44
    s_mov_b64 s[96:97], vcc
    v_add_u32_e64 v44, -1, v44
    v_cmp_gt_u32 vcc, 0x3200, v44
    s_or_b64 s[96:97], s[96:97], vcc
L_tl_94:
    s_cmp_eq_u64 s[96:97], 0
    s_cbranch_scc1 L_td_95
    s_ff1_i32_b64 s98, s[96:97]
    s_bitset0_b64 s[96:97], s98
    v_readlane_b32 s99, v6, s98
    s_and_b32 s99, s99, 0xffff0000
    s_call_b64 s[58:59], L_eval
    s_mov_b32 m0, s98
    s_nop 1
    v_writelane_b32 v21, s101, m0
    s_branch L_tl_94
L_td_95:
    v_bfe_u32 v44, v7, 0, 15
    v_cmp_lt_u32 vcc, 0x41ff, v44
    s_mov_b64 s[96:97], vcc
    v_add_u32_e64 v44, -1, v44
    v_cmp_gt_u32 vcc, 0x3200, v44
    s_or_b64 s[96:97], s[96:97], vcc
L_tl_96:
    s_cmp_eq_u64 s[96:97], 0
    s_cbranch_scc1 L_td_97
    s_ff1_i32_b64 s98, s[96:97]
    s_bitset0_b64 s[96:97], s98
    v_readlane_b32 s99, v7, s98
    s_lshl_b32 s99, s99, 16
    s_call_b64 s[58:59], L_eval
    s_mov_b32 m0, s98
    s_nop 0
    s_nop 0
    v_writelane_b32 v22, s101, m0
    s_branch L_tl_96
L_td_97:
    v_bfe_u32 v44, v7, 16, 15
    v_cmp_lt_u32 vcc, 0x41ff, v44
    s_mov_b64 s[96:97], vcc
    v_add_u32_e64 v44, -1, v44
    v_cmp_gt_u32 vcc, 0x3200, v44
    s_or_b64 s[96:97], s[96:97], vcc
L_tl_98:
    s_cmp_eq_u64 s[96:97], 0
    s_cbranch_scc1 L_td_99
    s_ff1_i32_b64 s98, s[96:97]
    s_bitset0_b64 s[96:97], s98
    v_readlane_b32 s99, v7, s98
    s_and_b32 s99, s99, 0xffff0000
    s_call_b64 s[58:59], L_eval
    s_mov_b32 m0, s98
    s_nop 1
    v_writelane_b32 v23, s101, m0
    s_branch L_tl_98
L_td_99:
    s_branch L_tinyb
L_eval:
    v_mov_b32_e64 v45, 0
    s_mov_b32 s100, 0
    s_mov_b32 s22, 2752
L_evl:
    s_lshr_b32 s101, s100, 2
    s_lshl_b32 s101, s101, 10
    s_and_b32 s27, s100, 3
    s_lshl_b32 s27, s27, 2
    s_add_u32 s101, s101, s27
    s_mov_b32 s20, s44
    s_mov_b32 s21, s45
    buffer_load_dword v40, v0, s[20:23], s101 offen
    s_mov_b32 s20, s46
    s_mov_b32 s21, s47
    buffer_load_dword v41, v0, s[20:23], s101 offen
    s_mov_b32 s20, s48
    s_mov_b32 s21, s49
    buffer_load_dword v42, v0, s[20:23], s101 offen
    s_waitcnt vmcnt(0)
    v_lshlrev_b32 v43, 16, v40
    v_lshlrev_b32 v44, 16, v41
    v_fma_f32 v43, v43, s99, v44
    v_mul_f32 v44, v43, v43
    v_mul_f32 v44, 0xbdd2d3e8, v44
    v_add_f32 v44, 0xc0135761, v44
    v_mul_f32 v44, v44, v43
    v_exp_f32 v44, v44
    s_nop 0
    v_add_f32 v44, 1.0, v44
    v_rcp_f32 v44, v44
    s_nop 0
    v_mul_f32 v43, v43, v44
    v_lshlrev_b32 v44, 16, v42
    v_fmac_f32 v45, v43, v44
    v_and_b32 v43, 0xffff0000, v40
    v_and_b32 v44, 0xffff0000, v41
    v_fma_f32 v43, v43, s99, v44
    v_mul_f32_e64 v44, v43, v43
    v_mul_f32 v44, 0xbdd2d3e8, v44
    v_add_f32 v44, 0xc0135761, v44
    v_mul_f32 v44, v44, v43
    v_exp_f32 v44, v44
    s_nop 0
    v_add_f32 v44, 1.0, v44
    v_rcp_f32 v44, v44
    s_nop 0
    v_mul_f32 v43, v43, v44
    v_and_b32 v44, 0xffff0000, v42
    v_fmac_f32 v45, v43, v44
    s_add_u32 s100, s100, 1
    s_cmp_lt_u32 s100, 12
    s_cbranch_scc1 L_evl
    s_mov_b32 s20, s50
    s_mov_b32 s21, s51
    s_mov_b32 s22, 2
    v_mov_b32 v41, 0
    buffer_load_ushort v40, v41, s[20:23], 0 offen
    v_add_f32_dpp v45, v45, v45 row_ror:1 row_mask:0xf bank_mask:0xf
    s_nop 1
    v_add_f32_dpp v45, v45, v45 row_ror:2 row_mask:0xf bank_mask:0xf
    s_nop 1
    v_add_f32_dpp v45, v45, v45 row_ror:4 row_mask:0xf bank_mask:0xf
    s_nop 1
    v_add_f32_dpp v45, v45, v45 row_ror:8 row_mask:0xf bank_mask:0xf
    v_mov_b32 v44, v45
    s_nop 1
    v_permlane16_swap_b32 v44, v45
    v_add_f32 v45, v45, v44
    v_mov_b32 v44, v45
    s_nop 1
    v_permlane32_swap_b32 v44, v45
    v_add_f32 v45, v45, v44
    s_waitcnt vmcnt(0)
    v_lshlrev_b32 v40, 16, v40
    v_add_f32 v45, v45, v40
    v_cvt_pk_bf16_f32 v45, v45, 0
    s_nop 0
    v_readfirstlane_b32 s101, v45
    s_setpc_b64 s[58:59]
L_slow_52:
    buffer_store_dword v40, v44, s[16:19], s94 offen sc1
    s_branch L_slowb_53
L_Qr_57:
    s_sub_u32 s26, s26, 1
    s_cbranch_scc1 L_fail
    s_mov_b64 exec, vcc
    buffer_load_dwordx4 v[8:11], v0, s[16:19], s95 offen offset:0 sc1
    buffer_load_dwordx4 v[12:15], v0, s[16:19], s95 offen offset:1024 sc1
    s_mov_b64 exec, -1
    s_branch L_Qw_55
L_seh_59:
    s_bitcmp1_b32 s7, 0
    s_cbranch_scc1 L_o_100
    s_call_b64 s[58:59], L_nxt
    s_call_b64 s[58:59], L_nxt
    s_call_b64 s[58:59], L_nxt
L_o_100:
    s_branch L_seb_60
L_gbr_62:
    s_sub_u32 s26, s26, 1
    s_cbranch_scc1 L_fail
    buffer_load_dwordx2 v[6:7], v5, s[16:19], s29 offen sc1
    s_waitcnt vmcnt(0)
    s_branch L_gbc_63
L_grr_69:
    s_sub_u32 s26, s26, 1
    s_cbranch_scc1 L_fail
    v_bfe_u32 v24, v0, 4, 3
    v_lshlrev_b32_e64 v24, 2, v24
    buffer_load_dword v25, v24, s[16:19], s28 offen sc1
    s_waitcnt vmcnt(0)
    s_branch L_grc_68
L_tbr_73:
    s_sub_u32 s26, s26, 1
    s_cbranch_scc1 L_fail
    buffer_load_dwordx4 v[48:51], v0, s[16:19], s28 offen offset:0 sc1
    buffer_load_dwordx4 v[52:55], v0, s[16:19], s28 offen offset:1024 sc1
    buffer_load_dwordx4 v[56:59], v0, s[16:19], s28 offen offset:2048 sc1
    buffer_load_dwordx4 v[60:63], v0, s[16:19], s28 offen offset:3072 sc1
    s_waitcnt vmcnt(0)
    s_branch L_tbc_72
L_codeend:
.section .rodata,"a"
.p2align 6
.amdhsa_kernel interleave_layers__gqa_block_cached__mixer_token_mlp__decode_kernel
  .amdhsa_next_free_vgpr 512
  .amdhsa_next_free_sgpr 102
  .amdhsa_accum_offset 256
  .amdhsa_group_segment_fixed_size 0
  .amdhsa_kernarg_size 104
  .amdhsa_user_sgpr_count 2
  .amdhsa_user_sgpr_kernarg_segment_ptr 1
  .amdhsa_system_sgpr_workgroup_id_x 1
  .amdhsa_float_denorm_mode_32 3
.end_amdhsa_kernel
```
